```python
import torch

def _softmax(x, axis=-1):
    return torch.softmax(x, dim=axis)
def _gelu(x):
    return torch.nn.functional.gelu(x, approximate="tanh")
def _silu(x):
    return torch.nn.functional.silu(x)
def _sigmoid(x):
    return torch.sigmoid(x)
def _layernorm(x, axis=-1, eps=1e-5):
    m = x.mean(dim=axis, keepdim=True)
    v = x.var(dim=axis, keepdim=True, unbiased=False)
    return (x - m) / torch.sqrt(v + eps)
def _scatter_add(tgt, idx, src, axis=0):
    return tgt.clone().index_add_(axis, idx, src)
def _segment_sum(src, seg, n):
    out = torch.zeros((n,) + src.shape[1:], dtype=src.dtype)
    return out.index_add_(0, seg, src)
def _pad(x, pw):
    flat = tuple(v for pair in reversed(pw) for v in pair)
    return torch.nn.functional.pad(x, flat)

kernel_name = 'standalone__gqa_block_cached__near_ridge'

def setup_inputs():

    _w = (lambda a: (lambda t: t.to(torch.bfloat16) if t.is_floating_point() else t)(torch.as_tensor(a)))
    B, Sq, D = 16, 48, 576
    Hq, Hkv, Sk, Dh = 32, 16, 48, 128
    assert Hq % Hkv == 0, (Hq, Hkv)
    return {
        "x": _w((lambda *s: torch.randn(*s, dtype=torch.bfloat16) * 0.8)(B, Sq, D)),
        "k_cache": _w((lambda *s: torch.randn(*s, dtype=torch.bfloat16) * 0.8)(B, Hkv, Sk, Dh)),
        "v_cache": _w((lambda *s: torch.randn(*s, dtype=torch.bfloat16) * 0.05)(B, Hkv, Sk, Dh)),
        "wq": _w((lambda *s: torch.randn(*s, dtype=torch.bfloat16) * 0.8)(D, Hq * Dh) * (D ** -0.5)),
        "wo": _w((lambda *s: torch.randn(*s, dtype=torch.bfloat16) * 0.05)(Hq * Dh, D) * ((Hq * Dh) ** -0.5)),
    }

def reference(x, k_cache, v_cache, wq, wo):
    B, Sq, D = x.shape
    Hq, Dh = 32, 128
    Hkv = k_cache.shape[1]
    rep = Hq // Hkv
    q = (lambda x, *d: x.permute(*d))((x @ wq).reshape(B, Sq, Hq, Dh), 0, 2, 1, 3)
    k = (lambda x, n, axis: torch.repeat_interleave(x, n, dim=axis))(k_cache, rep, axis=1)
    v = (lambda x, n, axis: torch.repeat_interleave(x, n, dim=axis))(v_cache, rep, axis=1)
    scores = torch.einsum("bhqd,bhkd->bhqk", q, k) * (Dh ** -0.5)
    p = _softmax(scores, axis=-1)
    o = torch.einsum("bhqk,bhkd->bhqd", p, v)
    return (lambda x, *d: x.permute(*d))(o, 0, 2, 1, 3).reshape(B, Sq, Hq * Dh) @ wo
```

```asm
; @launch grid=(256,1,1) block=(512,1,1) lds=163840
.amdgcn_target "amdgcn-amd-amdhsa--gfx950"
.text

.globl standalone__gqa_block_cached__near_ridge_kernel
.p2align 8
.type standalone__gqa_block_cached__near_ridge_kernel,@function
standalone__gqa_block_cached__near_ridge_kernel:
s_cmp_ge_u32 s2, 256
s_cbranch_scc1 L_end
s_load_dwordx2 s[24:25], s[0:1], 0
s_load_dwordx2 s[28:29], s[0:1], 24
s_load_dwordx4 s[4:7], s[0:1], 8
s_load_dwordx8 s[8:15], s[0:1], 32
v_lshrrev_b32 v1, 6, v0
v_and_b32 v0, 63, v0
v_readfirstlane_b32 s20, v1
s_xor_b32 s20, s20, 4
s_and_b32 s21, s2, 7
s_bfe_u32 s22, s2, 0x20003
s_lshr_b32 s23, s2, 5
v_and_b32 v1, 15, v0
v_lshrrev_b32 v2, 4, v0
s_cmp_eq_u32 s20, 0
s_cbranch_scc1 L_tr0
s_cmp_lt_u32 s20, 4
s_cbranch_scc1 L_comp
s_cmp_gt_u32 s20, 4
s_cbranch_scc1 L_help
s_getpc_b64 s[66:67]
L_pc:
s_sub_u32 s66, s66, L_pc-standalone__gqa_block_cached__near_ridge_kernel
s_subb_u32 s67, s67, 0
s_lshr_b32 s3, s2, 3
s_lshl_b32 s3, s3, 7
v_lshlrev_b32 v100, 12, v0
v_add_u32 v100, s3, v100
v_mov_b32 v103, s67
v_add_co_u32 v102, vcc, s66, v100
s_nop 1
v_addc_co_u32 v103, vcc, 0, v103, vcc
v_cmp_gt_u32 vcc, L_codeend-standalone__gqa_block_cached__near_ridge_kernel, v100
s_and_saveexec_b64 s[64:65], vcc
global_load_dword v101, v[102:103], off
s_mov_b64 exec, s[64:65]
s_mov_b32 s26, 884736
s_mov_b32 s27, 0x20000
s_mov_b32 s30, 4718592
s_mov_b32 s31, 0x20000
v_lshrrev_b32 v3, 3, v0
v_and_b32 v4, 7, v0
v_mul_u32_u24 v5, 1152, v3
v_xor_b32 v32, v4, v2
v_lshl_add_u32 v8, v32, 4, v5
v_xor_b32 v7, 64, v8
v_add_u32 v9, 8192, v7
v_add_u32 v10, 16384, v8
v_add_u32 v11, 16384, v9
v_lshlrev_b32 v6, 1, v2
v_xor_b32 v6, v6, v1
v_lshlrev_b32 v6, 4, v6
v_lshl_add_u32 v12, v2, 13, v6
v_add_u32 v13, 31744, v12
v_xor_b32 v7, 128, v12
v_add_u32 v14, 63488, v7
v_add_u32 v15, 95232, v7
s_add_u32 s17, s22, s23
s_mul_i32 s3, s17, 43
s_lshr_b32 s3, s3, 7
s_mul_i32 s3, s3, 3
s_sub_u32 s17, s17, s3
s_mul_i32 s17, s17, 3
s_mul_i32 s52, s23, 110592
s_lshl_b32 s53, s21, 10
s_lshl_b32 s3, s22, 8
s_add_u32 s53, s53, s3
s_waitcnt lgkmcnt(0)
s_lshl_b32 s57, s17, 7
s_add_u32 s57, s57, s52
s_mov_b32 m0, 98304
s_nop 0
buffer_load_dwordx4 v8, s[24:27], s57 offen offset:0  lds
buffer_load_dwordx4 v9, s[24:27], s57 offen offset:1024  lds
buffer_load_dwordx4 v10, s[24:27], s57 offen offset:2048  lds
buffer_load_dwordx4 v11, s[24:27], s57 offen offset:3072  lds
s_mov_b32 m0, 102400
s_add_u32 s57, s57, 36864
buffer_load_dwordx4 v8, s[24:27], s57 offen offset:0  lds
buffer_load_dwordx4 v9, s[24:27], s57 offen offset:1024  lds
buffer_load_dwordx4 v10, s[24:27], s57 offen offset:2048  lds
buffer_load_dwordx4 v11, s[24:27], s57 offen offset:3072  lds
s_mov_b32 m0, 106496
s_add_u32 s57, s57, 36864
buffer_load_dwordx4 v8, s[24:27], s57 offen offset:0  lds
buffer_load_dwordx4 v9, s[24:27], s57 offen offset:1024  lds
buffer_load_dwordx4 v10, s[24:27], s57 offen offset:2048  lds
s_branch L_ov0
L_tr0:
s_branch L_comp
L_ov0:
buffer_load_dwordx4 v11, s[24:27], s57 offen offset:3072  lds
s_lshl_b32 s57, s17, 19
s_add_u32 s57, s57, s53
s_mov_b32 m0, 0
s_nop 0
buffer_load_dwordx4 v12, s[28:31], s57 offen offset:0  lds
buffer_load_dwordx4 v13, s[28:31], s57 offen offset:1024  lds
buffer_load_dwordx4 v14, s[28:31], s57 offen offset:2048  lds
buffer_load_dwordx4 v15, s[28:31], s57 offen offset:3072  lds
s_mov_b32 m0, 4096
s_add_u32 s57, s57, 131072
buffer_load_dwordx4 v12, s[28:31], s57 offen offset:0  lds
buffer_load_dwordx4 v13, s[28:31], s57 offen offset:1024  lds
buffer_load_dwordx4 v14, s[28:31], s57 offen offset:2048  lds
buffer_load_dwordx4 v15, s[28:31], s57 offen offset:3072  lds
s_mov_b32 m0, 8192
s_add_u32 s57, s57, 131072
buffer_load_dwordx4 v12, s[28:31], s57 offen offset:0  lds
buffer_load_dwordx4 v13, s[28:31], s57 offen offset:1024  lds
buffer_load_dwordx4 v14, s[28:31], s57 offen offset:2048  lds
buffer_load_dwordx4 v15, s[28:31], s57 offen offset:3072  lds
s_mov_b32 m0, 12288
s_add_u32 s57, s57, 131072
buffer_load_dwordx4 v12, s[28:31], s57 offen offset:0  lds
buffer_load_dwordx4 v13, s[28:31], s57 offen offset:1024  lds
buffer_load_dwordx4 v14, s[28:31], s57 offen offset:2048  lds
buffer_load_dwordx4 v15, s[28:31], s57 offen offset:3072  lds
s_add_u32 s17, s17, 1
s_cmp_eq_u32 s17, 9
s_cselect_b32 s17, 0, s17
s_lshl_b32 s57, s17, 7
s_add_u32 s57, s57, s52
s_mov_b32 m0, 73728
s_nop 0
buffer_load_dwordx4 v8, s[24:27], s57 offen offset:0  lds
buffer_load_dwordx4 v9, s[24:27], s57 offen offset:1024  lds
buffer_load_dwordx4 v10, s[24:27], s57 offen offset:2048  lds
buffer_load_dwordx4 v11, s[24:27], s57 offen offset:3072  lds
s_mov_b32 m0, 77824
s_add_u32 s57, s57, 36864
buffer_load_dwordx4 v8, s[24:27], s57 offen offset:0  lds
buffer_load_dwordx4 v9, s[24:27], s57 offen offset:1024  lds
buffer_load_dwordx4 v10, s[24:27], s57 offen offset:2048  lds
buffer_load_dwordx4 v11, s[24:27], s57 offen offset:3072  lds
s_mov_b32 m0, 81920
s_add_u32 s57, s57, 36864
buffer_load_dwordx4 v8, s[24:27], s57 offen offset:0  lds
buffer_load_dwordx4 v9, s[24:27], s57 offen offset:1024  lds
buffer_load_dwordx4 v10, s[24:27], s57 offen offset:2048  lds
buffer_load_dwordx4 v11, s[24:27], s57 offen offset:3072  lds
s_lshl_b32 s57, s17, 19
s_add_u32 s57, s57, s53
s_mov_b32 m0, 16384
s_nop 0
buffer_load_dwordx4 v12, s[28:31], s57 offen offset:0  lds
buffer_load_dwordx4 v13, s[28:31], s57 offen offset:1024  lds
buffer_load_dwordx4 v14, s[28:31], s57 offen offset:2048  lds
buffer_load_dwordx4 v15, s[28:31], s57 offen offset:3072  lds
s_mov_b32 m0, 20480
s_add_u32 s57, s57, 131072
buffer_load_dwordx4 v12, s[28:31], s57 offen offset:0  lds
buffer_load_dwordx4 v13, s[28:31], s57 offen offset:1024  lds
buffer_load_dwordx4 v14, s[28:31], s57 offen offset:2048  lds
buffer_load_dwordx4 v15, s[28:31], s57 offen offset:3072  lds
s_mov_b32 m0, 24576
s_add_u32 s57, s57, 131072
buffer_load_dwordx4 v12, s[28:31], s57 offen offset:0  lds
buffer_load_dwordx4 v13, s[28:31], s57 offen offset:1024  lds
buffer_load_dwordx4 v14, s[28:31], s57 offen offset:2048  lds
buffer_load_dwordx4 v15, s[28:31], s57 offen offset:3072  lds
s_mov_b32 m0, 28672
s_add_u32 s57, s57, 131072
buffer_load_dwordx4 v12, s[28:31], s57 offen offset:0  lds
buffer_load_dwordx4 v13, s[28:31], s57 offen offset:1024  lds
buffer_load_dwordx4 v14, s[28:31], s57 offen offset:2048  lds
buffer_load_dwordx4 v15, s[28:31], s57 offen offset:3072  lds
s_add_u32 s17, s17, 1
s_cmp_eq_u32 s17, 9
s_cselect_b32 s17, 0, s17
s_lshl_b32 s57, s17, 7
s_add_u32 s57, s57, s52
s_mov_b32 m0, 49152
s_nop 0
buffer_load_dwordx4 v8, s[24:27], s57 offen offset:0  lds
buffer_load_dwordx4 v9, s[24:27], s57 offen offset:1024  lds
buffer_load_dwordx4 v10, s[24:27], s57 offen offset:2048  lds
buffer_load_dwordx4 v11, s[24:27], s57 offen offset:3072  lds
s_mov_b32 m0, 53248
s_add_u32 s57, s57, 36864
s_waitcnt vmcnt(44)
buffer_load_dwordx4 v8, s[24:27], s57 offen offset:0  lds
buffer_load_dwordx4 v9, s[24:27], s57 offen offset:1024  lds
buffer_load_dwordx4 v10, s[24:27], s57 offen offset:2048  lds
buffer_load_dwordx4 v11, s[24:27], s57 offen offset:3072  lds
s_mov_b32 m0, 57344
s_add_u32 s57, s57, 36864
buffer_load_dwordx4 v8, s[24:27], s57 offen offset:0  lds
buffer_load_dwordx4 v9, s[24:27], s57 offen offset:1024  lds
buffer_load_dwordx4 v10, s[24:27], s57 offen offset:2048  lds
buffer_load_dwordx4 v11, s[24:27], s57 offen offset:3072  lds
s_lshl_b32 s57, s17, 19
s_add_u32 s57, s57, s53
s_mov_b32 m0, 32768
s_waitcnt vmcnt(40)
s_barrier
buffer_load_dwordx4 v12, s[28:31], s57 offen offset:0  lds
buffer_load_dwordx4 v13, s[28:31], s57 offen offset:1024  lds
buffer_load_dwordx4 v14, s[28:31], s57 offen offset:2048  lds
buffer_load_dwordx4 v15, s[28:31], s57 offen offset:3072  lds
s_mov_b32 m0, 36864
s_add_u32 s57, s57, 131072
buffer_load_dwordx4 v12, s[28:31], s57 offen offset:0  lds
buffer_load_dwordx4 v13, s[28:31], s57 offen offset:1024  lds
buffer_load_dwordx4 v14, s[28:31], s57 offen offset:2048  lds
buffer_load_dwordx4 v15, s[28:31], s57 offen offset:3072  lds
s_mov_b32 m0, 40960
s_add_u32 s57, s57, 131072
buffer_load_dwordx4 v12, s[28:31], s57 offen offset:0  lds
buffer_load_dwordx4 v13, s[28:31], s57 offen offset:1024  lds
buffer_load_dwordx4 v14, s[28:31], s57 offen offset:2048  lds
buffer_load_dwordx4 v15, s[28:31], s57 offen offset:3072  lds
s_mov_b32 m0, 45056
s_add_u32 s57, s57, 131072
buffer_load_dwordx4 v12, s[28:31], s57 offen offset:0  lds
buffer_load_dwordx4 v13, s[28:31], s57 offen offset:1024  lds
buffer_load_dwordx4 v14, s[28:31], s57 offen offset:2048  lds
buffer_load_dwordx4 v15, s[28:31], s57 offen offset:3072  lds
s_add_u32 s17, s17, 1
s_cmp_eq_u32 s17, 9
s_cselect_b32 s17, 0, s17
s_mov_b32 s32, s4
s_mov_b32 s33, s5
s_mov_b32 s34, 3145728
s_mov_b32 s35, 0x20000
s_mov_b32 s36, s6
s_mov_b32 s37, s7
s_mov_b32 s38, 3145728
s_mov_b32 s39, 0x20000
s_mov_b32 s40, s8
s_mov_b32 s41, s9
s_mov_b32 s42, 4718592
s_mov_b32 s43, 0x20000
s_mov_b32 s44, s14
s_mov_b32 s45, s15
s_mov_b32 s46, 268435456
s_mov_b32 s47, 0x20000
v_mul_u32_u24 v7, 1152, v2
v_add_u32 v16, v7, v6
v_add_u32 v17, 3584, v16
v_xor_b32 v6, 128, v6
v_add_u32 v7, v7, v6
v_add_u32 v18, 7168, v7
v_add_u32 v19, 10752, v7
v_xor_b32 v6, v1, v2
v_lshlrev_b32 v6, 4, v6
v_lshl_add_u32 v20, v2, 8, v6
v_xor_b32 v21, 64, v20
v_xor_b32 v22, 128, v20
v_xor_b32 v23, 192, v20
v_and_b32 v6, 1, v2
v_lshlrev_b32 v6, 1, v6
v_xor_b32 v6, v6, v4
v_lshl_add_u32 v24, v6, 4, v5
v_xor_b32 v7, 64, v24
v_add_u32 v25, 8192, v7
v_add_u32 v26, 16384, v24
v_add_u32 v27, 16384, v25
v_lshlrev_b32 v6, 8, v3
v_lshl_add_u32 v28, v32, 4, v6
v_xor_b32 v7, 64, v28
v_add_u32 v29, 1024, v7
v_add_u32 v30, 2048, v28
v_add_u32 v31, 2048, v29
s_mov_b32 s3, 36864
v_add_u32 v44, s3, v8
v_add_u32 v45, s3, v9
v_add_u32 v46, s3, v10
v_add_u32 v47, s3, v11
s_mov_b32 s3, 73728
v_add_u32 v48, s3, v8
v_add_u32 v49, s3, v9
v_add_u32 v50, s3, v10
v_add_u32 v51, s3, v11
s_mov_b32 s3, 131072
v_add_u32 v56, s3, v12
v_add_u32 v57, s3, v13
v_add_u32 v58, s3, v14
v_add_u32 v59, s3, v15
s_mov_b32 s3, 262144
v_add_u32 v60, s3, v12
v_add_u32 v61, s3, v13
v_add_u32 v62, s3, v14
v_add_u32 v63, s3, v15
s_mov_b32 s3, 393216
v_add_u32 v64, s3, v12
v_add_u32 v65, s3, v13
v_add_u32 v66, s3, v14
v_add_u32 v67, s3, v15
s_mov_b32 s3, 18432
v_add_u32 v72, s3, v16
v_add_u32 v73, s3, v17
v_add_u32 v74, s3, v18
v_add_u32 v75, s3, v19
s_mov_b32 s3, 36864
v_add_u32 v76, s3, v16
v_add_u32 v77, s3, v17
v_add_u32 v78, s3, v18
v_add_u32 v79, s3, v19
s_mov_b32 s3, 55296
v_add_u32 v80, s3, v16
v_add_u32 v81, s3, v17
v_add_u32 v82, s3, v18
v_add_u32 v83, s3, v19
s_and_b32 s16, s22, 1
s_xor_b32 s16, s16, s23
s_and_b32 s16, s16, 3
s_and_b32 s59, s22, 2
s_lshl1_add_u32 s59, s59, s16
s_lshl_b32 s54, s23, 5
s_lshl_b32 s3, s21, 1
s_add_u32 s54, s54, s3
s_mul_i32 s60, s3, 294912
s_add_u32 s62, s60, 1024
s_lshl_b32 s3, s22, 8
s_add_u32 s60, s60, s3
s_lshl_b32 s57, s17, 7
s_add_u32 s57, s57, s52
s_mov_b32 m0, 61440
s_nop 0
buffer_load_dwordx4 v8, s[24:27], s57 offen offset:0  lds
buffer_load_dwordx4 v9, s[24:27], s57 offen offset:1024  lds
buffer_load_dwordx4 v10, s[24:27], s57 offen offset:2048  lds
buffer_load_dwordx4 v11, s[24:27], s57 offen offset:3072  lds
s_mov_b32 m0, 65536
s_waitcnt vmcnt(44)
buffer_load_dwordx4 v44, s[24:27], s57 offen offset:0  lds
buffer_load_dwordx4 v45, s[24:27], s57 offen offset:1024  lds
buffer_load_dwordx4 v46, s[24:27], s57 offen offset:2048  lds
buffer_load_dwordx4 v47, s[24:27], s57 offen offset:3072  lds
s_mov_b32 m0, 69632
s_nop 0
buffer_load_dwordx4 v48, s[24:27], s57 offen offset:0  lds
buffer_load_dwordx4 v49, s[24:27], s57 offen offset:1024  lds
buffer_load_dwordx4 v50, s[24:27], s57 offen offset:2048  lds
buffer_load_dwordx4 v51, s[24:27], s57 offen offset:3072  lds
s_lshl_b32 s57, s17, 19
s_add_u32 s57, s57, s53
s_mov_b32 m0, 0
s_waitcnt vmcnt(40)
s_barrier
buffer_load_dwordx4 v12, s[28:31], s57 offen offset:0  lds
buffer_load_dwordx4 v13, s[28:31], s57 offen offset:1024  lds
buffer_load_dwordx4 v14, s[28:31], s57 offen offset:2048  lds
buffer_load_dwordx4 v15, s[28:31], s57 offen offset:3072  lds
s_mov_b32 m0, 4096
s_nop 0
buffer_load_dwordx4 v56, s[28:31], s57 offen offset:0  lds
buffer_load_dwordx4 v57, s[28:31], s57 offen offset:1024  lds
buffer_load_dwordx4 v58, s[28:31], s57 offen offset:2048  lds
buffer_load_dwordx4 v59, s[28:31], s57 offen offset:3072  lds
s_mov_b32 m0, 8192
s_nop 0
buffer_load_dwordx4 v60, s[28:31], s57 offen offset:0  lds
buffer_load_dwordx4 v61, s[28:31], s57 offen offset:1024  lds
buffer_load_dwordx4 v62, s[28:31], s57 offen offset:2048  lds
buffer_load_dwordx4 v63, s[28:31], s57 offen offset:3072  lds
s_mov_b32 m0, 12288
s_nop 0
buffer_load_dwordx4 v64, s[28:31], s57 offen offset:0  lds
buffer_load_dwordx4 v65, s[28:31], s57 offen offset:1024  lds
buffer_load_dwordx4 v66, s[28:31], s57 offen offset:2048  lds
buffer_load_dwordx4 v67, s[28:31], s57 offen offset:3072  lds
s_add_u32 s17, s17, 1
s_cmp_eq_u32 s17, 9
s_cselect_b32 s17, 0, s17
s_lshl_b32 s57, s17, 7
s_add_u32 s57, s57, s52
s_mov_b32 m0, 98304
s_nop 0
buffer_load_dwordx4 v8, s[24:27], s57 offen offset:0  lds
buffer_load_dwordx4 v9, s[24:27], s57 offen offset:1024  lds
buffer_load_dwordx4 v10, s[24:27], s57 offen offset:2048  lds
buffer_load_dwordx4 v11, s[24:27], s57 offen offset:3072  lds
s_mov_b32 m0, 102400
s_waitcnt vmcnt(44)
buffer_load_dwordx4 v44, s[24:27], s57 offen offset:0  lds
buffer_load_dwordx4 v45, s[24:27], s57 offen offset:1024  lds
buffer_load_dwordx4 v46, s[24:27], s57 offen offset:2048  lds
buffer_load_dwordx4 v47, s[24:27], s57 offen offset:3072  lds
s_mov_b32 m0, 106496
s_nop 0
buffer_load_dwordx4 v48, s[24:27], s57 offen offset:0  lds
buffer_load_dwordx4 v49, s[24:27], s57 offen offset:1024  lds
buffer_load_dwordx4 v50, s[24:27], s57 offen offset:2048  lds
buffer_load_dwordx4 v51, s[24:27], s57 offen offset:3072  lds
s_lshl_b32 s57, s17, 19
s_add_u32 s57, s57, s53
s_mov_b32 m0, 16384
s_waitcnt vmcnt(40)
s_barrier
buffer_load_dwordx4 v12, s[28:31], s57 offen offset:0  lds
buffer_load_dwordx4 v13, s[28:31], s57 offen offset:1024  lds
buffer_load_dwordx4 v14, s[28:31], s57 offen offset:2048  lds
buffer_load_dwordx4 v15, s[28:31], s57 offen offset:3072  lds
s_mov_b32 m0, 20480
s_nop 0
buffer_load_dwordx4 v56, s[28:31], s57 offen offset:0  lds
buffer_load_dwordx4 v57, s[28:31], s57 offen offset:1024  lds
buffer_load_dwordx4 v58, s[28:31], s57 offen offset:2048  lds
buffer_load_dwordx4 v59, s[28:31], s57 offen offset:3072  lds
s_mov_b32 m0, 24576
s_nop 0
buffer_load_dwordx4 v60, s[28:31], s57 offen offset:0  lds
buffer_load_dwordx4 v61, s[28:31], s57 offen offset:1024  lds
buffer_load_dwordx4 v62, s[28:31], s57 offen offset:2048  lds
buffer_load_dwordx4 v63, s[28:31], s57 offen offset:3072  lds
s_mov_b32 m0, 28672
s_nop 0
buffer_load_dwordx4 v64, s[28:31], s57 offen offset:0  lds
buffer_load_dwordx4 v65, s[28:31], s57 offen offset:1024  lds
buffer_load_dwordx4 v66, s[28:31], s57 offen offset:2048  lds
buffer_load_dwordx4 v67, s[28:31], s57 offen offset:3072  lds
s_add_u32 s17, s17, 1
s_cmp_eq_u32 s17, 9
s_cselect_b32 s17, 0, s17
s_lshl_b32 s57, s17, 7
s_add_u32 s57, s57, s52
s_mov_b32 m0, 73728
s_nop 0
buffer_load_dwordx4 v8, s[24:27], s57 offen offset:0  lds
buffer_load_dwordx4 v9, s[24:27], s57 offen offset:1024  lds
buffer_load_dwordx4 v10, s[24:27], s57 offen offset:2048  lds
buffer_load_dwordx4 v11, s[24:27], s57 offen offset:3072  lds
s_mov_b32 m0, 77824
s_waitcnt vmcnt(44)
buffer_load_dwordx4 v44, s[24:27], s57 offen offset:0  lds
buffer_load_dwordx4 v45, s[24:27], s57 offen offset:1024  lds
buffer_load_dwordx4 v46, s[24:27], s57 offen offset:2048  lds
buffer_load_dwordx4 v47, s[24:27], s57 offen offset:3072  lds
s_mov_b32 m0, 81920
s_nop 0
buffer_load_dwordx4 v48, s[24:27], s57 offen offset:0  lds
buffer_load_dwordx4 v49, s[24:27], s57 offen offset:1024  lds
buffer_load_dwordx4 v50, s[24:27], s57 offen offset:2048  lds
buffer_load_dwordx4 v51, s[24:27], s57 offen offset:3072  lds
s_lshl_b32 s57, s17, 19
s_add_u32 s57, s57, s53
s_mov_b32 m0, 32768
s_waitcnt vmcnt(40)
s_barrier
buffer_load_dwordx4 v12, s[28:31], s57 offen offset:0  lds
buffer_load_dwordx4 v13, s[28:31], s57 offen offset:1024  lds
buffer_load_dwordx4 v14, s[28:31], s57 offen offset:2048  lds
buffer_load_dwordx4 v15, s[28:31], s57 offen offset:3072  lds
s_mov_b32 m0, 36864
s_nop 0
buffer_load_dwordx4 v56, s[28:31], s57 offen offset:0  lds
buffer_load_dwordx4 v57, s[28:31], s57 offen offset:1024  lds
buffer_load_dwordx4 v58, s[28:31], s57 offen offset:2048  lds
buffer_load_dwordx4 v59, s[28:31], s57 offen offset:3072  lds
s_mov_b32 m0, 40960
s_nop 0
buffer_load_dwordx4 v60, s[28:31], s57 offen offset:0  lds
buffer_load_dwordx4 v61, s[28:31], s57 offen offset:1024  lds
buffer_load_dwordx4 v62, s[28:31], s57 offen offset:2048  lds
buffer_load_dwordx4 v63, s[28:31], s57 offen offset:3072  lds
s_mov_b32 m0, 45056
s_nop 0
buffer_load_dwordx4 v64, s[28:31], s57 offen offset:0  lds
buffer_load_dwordx4 v65, s[28:31], s57 offen offset:1024  lds
buffer_load_dwordx4 v66, s[28:31], s57 offen offset:2048  lds
buffer_load_dwordx4 v67, s[28:31], s57 offen offset:3072  lds
s_add_u32 s17, s17, 1
s_cmp_eq_u32 s17, 9
s_cselect_b32 s17, 0, s17
s_lshl_b32 s57, s17, 7
s_add_u32 s57, s57, s52
s_mov_b32 m0, 49152
s_nop 0
buffer_load_dwordx4 v8, s[24:27], s57 offen offset:0  lds
buffer_load_dwordx4 v9, s[24:27], s57 offen offset:1024  lds
buffer_load_dwordx4 v10, s[24:27], s57 offen offset:2048  lds
buffer_load_dwordx4 v11, s[24:27], s57 offen offset:3072  lds
s_mov_b32 m0, 53248
s_waitcnt vmcnt(44)
buffer_load_dwordx4 v44, s[24:27], s57 offen offset:0  lds
buffer_load_dwordx4 v45, s[24:27], s57 offen offset:1024  lds
buffer_load_dwordx4 v46, s[24:27], s57 offen offset:2048  lds
buffer_load_dwordx4 v47, s[24:27], s57 offen offset:3072  lds
s_mov_b32 m0, 57344
s_nop 0
buffer_load_dwordx4 v48, s[24:27], s57 offen offset:0  lds
buffer_load_dwordx4 v49, s[24:27], s57 offen offset:1024  lds
buffer_load_dwordx4 v50, s[24:27], s57 offen offset:2048  lds
buffer_load_dwordx4 v51, s[24:27], s57 offen offset:3072  lds
s_lshl_b32 s57, s17, 19
s_add_u32 s57, s57, s53
s_mov_b32 m0, 0
s_waitcnt vmcnt(40)
s_barrier
buffer_load_dwordx4 v12, s[28:31], s57 offen offset:0  lds
buffer_load_dwordx4 v13, s[28:31], s57 offen offset:1024  lds
buffer_load_dwordx4 v14, s[28:31], s57 offen offset:2048  lds
buffer_load_dwordx4 v15, s[28:31], s57 offen offset:3072  lds
s_mov_b32 m0, 4096
s_nop 0
buffer_load_dwordx4 v56, s[28:31], s57 offen offset:0  lds
buffer_load_dwordx4 v57, s[28:31], s57 offen offset:1024  lds
buffer_load_dwordx4 v58, s[28:31], s57 offen offset:2048  lds
buffer_load_dwordx4 v59, s[28:31], s57 offen offset:3072  lds
s_mov_b32 m0, 8192
s_nop 0
buffer_load_dwordx4 v60, s[28:31], s57 offen offset:0  lds
buffer_load_dwordx4 v61, s[28:31], s57 offen offset:1024  lds
buffer_load_dwordx4 v62, s[28:31], s57 offen offset:2048  lds
buffer_load_dwordx4 v63, s[28:31], s57 offen offset:3072  lds
s_mov_b32 m0, 12288
s_nop 0
buffer_load_dwordx4 v64, s[28:31], s57 offen offset:0  lds
buffer_load_dwordx4 v65, s[28:31], s57 offen offset:1024  lds
buffer_load_dwordx4 v66, s[28:31], s57 offen offset:2048  lds
buffer_load_dwordx4 v67, s[28:31], s57 offen offset:3072  lds
s_add_u32 s17, s17, 1
s_cmp_eq_u32 s17, 9
s_cselect_b32 s17, 0, s17
s_lshl_b32 s57, s17, 7
s_add_u32 s57, s57, s52
s_mov_b32 m0, 61440
s_nop 0
buffer_load_dwordx4 v8, s[24:27], s57 offen offset:0  lds
buffer_load_dwordx4 v9, s[24:27], s57 offen offset:1024  lds
buffer_load_dwordx4 v10, s[24:27], s57 offen offset:2048  lds
buffer_load_dwordx4 v11, s[24:27], s57 offen offset:3072  lds
s_mov_b32 m0, 65536
s_waitcnt vmcnt(44)
buffer_load_dwordx4 v44, s[24:27], s57 offen offset:0  lds
buffer_load_dwordx4 v45, s[24:27], s57 offen offset:1024  lds
buffer_load_dwordx4 v46, s[24:27], s57 offen offset:2048  lds
buffer_load_dwordx4 v47, s[24:27], s57 offen offset:3072  lds
s_mov_b32 m0, 69632
s_nop 0
buffer_load_dwordx4 v48, s[24:27], s57 offen offset:0  lds
buffer_load_dwordx4 v49, s[24:27], s57 offen offset:1024  lds
buffer_load_dwordx4 v50, s[24:27], s57 offen offset:2048  lds
buffer_load_dwordx4 v51, s[24:27], s57 offen offset:3072  lds
s_lshl_b32 s57, s17, 19
s_add_u32 s57, s57, s53
s_mov_b32 m0, 16384
s_waitcnt vmcnt(40)
s_barrier
buffer_load_dwordx4 v12, s[28:31], s57 offen offset:0  lds
buffer_load_dwordx4 v13, s[28:31], s57 offen offset:1024  lds
buffer_load_dwordx4 v14, s[28:31], s57 offen offset:2048  lds
buffer_load_dwordx4 v15, s[28:31], s57 offen offset:3072  lds
s_mov_b32 m0, 20480
s_nop 0
buffer_load_dwordx4 v56, s[28:31], s57 offen offset:0  lds
buffer_load_dwordx4 v57, s[28:31], s57 offen offset:1024  lds
buffer_load_dwordx4 v58, s[28:31], s57 offen offset:2048  lds
buffer_load_dwordx4 v59, s[28:31], s57 offen offset:3072  lds
s_mov_b32 m0, 24576
s_nop 0
buffer_load_dwordx4 v60, s[28:31], s57 offen offset:0  lds
buffer_load_dwordx4 v61, s[28:31], s57 offen offset:1024  lds
buffer_load_dwordx4 v62, s[28:31], s57 offen offset:2048  lds
buffer_load_dwordx4 v63, s[28:31], s57 offen offset:3072  lds
s_mov_b32 m0, 28672
s_nop 0
buffer_load_dwordx4 v64, s[28:31], s57 offen offset:0  lds
buffer_load_dwordx4 v65, s[28:31], s57 offen offset:1024  lds
buffer_load_dwordx4 v66, s[28:31], s57 offen offset:2048  lds
buffer_load_dwordx4 v67, s[28:31], s57 offen offset:3072  lds
s_add_u32 s17, s17, 1
s_cmp_eq_u32 s17, 9
s_cselect_b32 s17, 0, s17
s_lshl_b32 s57, s17, 7
s_add_u32 s57, s57, s52
s_mov_b32 m0, 98304
s_nop 0
buffer_load_dwordx4 v8, s[24:27], s57 offen offset:0  lds
buffer_load_dwordx4 v9, s[24:27], s57 offen offset:1024  lds
buffer_load_dwordx4 v10, s[24:27], s57 offen offset:2048  lds
buffer_load_dwordx4 v11, s[24:27], s57 offen offset:3072  lds
s_mov_b32 m0, 102400
s_waitcnt vmcnt(44)
buffer_load_dwordx4 v44, s[24:27], s57 offen offset:0  lds
buffer_load_dwordx4 v45, s[24:27], s57 offen offset:1024  lds
buffer_load_dwordx4 v46, s[24:27], s57 offen offset:2048  lds
buffer_load_dwordx4 v47, s[24:27], s57 offen offset:3072  lds
s_mov_b32 m0, 106496
s_nop 0
buffer_load_dwordx4 v48, s[24:27], s57 offen offset:0  lds
buffer_load_dwordx4 v49, s[24:27], s57 offen offset:1024  lds
buffer_load_dwordx4 v50, s[24:27], s57 offen offset:2048  lds
buffer_load_dwordx4 v51, s[24:27], s57 offen offset:3072  lds
s_lshl_b32 s57, s17, 19
s_add_u32 s57, s57, s53
s_mov_b32 m0, 32768
s_waitcnt vmcnt(40)
s_barrier
buffer_load_dwordx4 v12, s[28:31], s57 offen offset:0  lds
buffer_load_dwordx4 v13, s[28:31], s57 offen offset:1024  lds
buffer_load_dwordx4 v14, s[28:31], s57 offen offset:2048  lds
buffer_load_dwordx4 v15, s[28:31], s57 offen offset:3072  lds
s_mov_b32 m0, 36864
s_nop 0
buffer_load_dwordx4 v56, s[28:31], s57 offen offset:0  lds
buffer_load_dwordx4 v57, s[28:31], s57 offen offset:1024  lds
buffer_load_dwordx4 v58, s[28:31], s57 offen offset:2048  lds
buffer_load_dwordx4 v59, s[28:31], s57 offen offset:3072  lds
s_mov_b32 m0, 40960
s_nop 0
buffer_load_dwordx4 v60, s[28:31], s57 offen offset:0  lds
buffer_load_dwordx4 v61, s[28:31], s57 offen offset:1024  lds
buffer_load_dwordx4 v62, s[28:31], s57 offen offset:2048  lds
buffer_load_dwordx4 v63, s[28:31], s57 offen offset:3072  lds
s_mov_b32 m0, 45056
s_nop 0
buffer_load_dwordx4 v64, s[28:31], s57 offen offset:0  lds
buffer_load_dwordx4 v65, s[28:31], s57 offen offset:1024  lds
buffer_load_dwordx4 v66, s[28:31], s57 offen offset:2048  lds
buffer_load_dwordx4 v67, s[28:31], s57 offen offset:3072  lds
s_add_u32 s17, s17, 1
s_cmp_eq_u32 s17, 9
s_cselect_b32 s17, 0, s17
s_lshr_b32 s3, s22, 1
s_add_u32 s57, s54, s3
s_mul_i32 s57, s57, 12288
s_mov_b32 m0, 73728
s_nop 0
buffer_load_dwordx4 v20, s[32:35], s57 offen offset:0  lds
buffer_load_dwordx4 v21, s[32:35], s57 offen offset:1024  lds
buffer_load_dwordx4 v22, s[32:35], s57 offen offset:2048  lds
buffer_load_dwordx4 v23, s[32:35], s57 offen offset:3072  lds
s_mov_b32 m0, 77824
s_add_u32 s57, s57, 4096
s_waitcnt vmcnt(44)
buffer_load_dwordx4 v20, s[32:35], s57 offen offset:0  lds
buffer_load_dwordx4 v21, s[32:35], s57 offen offset:1024  lds
buffer_load_dwordx4 v22, s[32:35], s57 offen offset:2048  lds
buffer_load_dwordx4 v23, s[32:35], s57 offen offset:3072  lds
s_mov_b32 m0, 81920
s_add_u32 s57, s57, 4096
buffer_load_dwordx4 v20, s[32:35], s57 offen offset:0  lds
buffer_load_dwordx4 v21, s[32:35], s57 offen offset:1024  lds
buffer_load_dwordx4 v22, s[32:35], s57 offen offset:2048  lds
buffer_load_dwordx4 v23, s[32:35], s57 offen offset:3072  lds
s_mov_b32 s61, s57
s_mov_b32 s57, s61
s_mov_b32 m0, 86016
s_add_u32 s57, s57, 188416
s_waitcnt vmcnt(40)
s_barrier
buffer_load_dwordx4 v20, s[32:35], s57 offen offset:0  lds
buffer_load_dwordx4 v21, s[32:35], s57 offen offset:1024  lds
buffer_load_dwordx4 v22, s[32:35], s57 offen offset:2048  lds
buffer_load_dwordx4 v23, s[32:35], s57 offen offset:3072  lds
s_mov_b32 m0, 90112
s_add_u32 s57, s57, 4096
buffer_load_dwordx4 v20, s[32:35], s57 offen offset:0  lds
buffer_load_dwordx4 v21, s[32:35], s57 offen offset:1024  lds
buffer_load_dwordx4 v22, s[32:35], s57 offen offset:2048  lds
buffer_load_dwordx4 v23, s[32:35], s57 offen offset:3072  lds
s_mov_b32 m0, 94208
s_add_u32 s57, s57, 4096
buffer_load_dwordx4 v20, s[32:35], s57 offen offset:0  lds
buffer_load_dwordx4 v21, s[32:35], s57 offen offset:1024  lds
buffer_load_dwordx4 v22, s[32:35], s57 offen offset:2048  lds
buffer_load_dwordx4 v23, s[32:35], s57 offen offset:3072  lds
s_lshr_b32 s3, s16, 2
s_xor_b32 s3, s3, 0
s_add_u32 s57, s54, s3
s_mul_i32 s57, s57, 12288
s_xor_b32 s3, s16, 0
s_and_b32 s3, s3, 1
s_lshl_b32 s3, s3, 7
s_add_u32 s57, s57, s3
s_mov_b32 m0, 110592
s_nop 0
buffer_load_dwordx4 v28, s[36:39], s57 offen offset:0  lds
buffer_load_dwordx4 v29, s[36:39], s57 offen offset:1024  lds
buffer_load_dwordx4 v30, s[36:39], s57 offen offset:2048  lds
buffer_load_dwordx4 v31, s[36:39], s57 offen offset:3072  lds
s_mov_b32 m0, 114688
s_add_u32 s57, s57, 8192
buffer_load_dwordx4 v28, s[36:39], s57 offen offset:0  lds
buffer_load_dwordx4 v29, s[36:39], s57 offen offset:1024  lds
s_mov_b32 m0, 116736
s_add_u32 s57, s57, 188416
buffer_load_dwordx4 v28, s[36:39], s57 offen offset:0  lds
buffer_load_dwordx4 v29, s[36:39], s57 offen offset:1024  lds
s_waitcnt vmcnt(44)
buffer_load_dwordx4 v30, s[36:39], s57 offen offset:2048  lds
buffer_load_dwordx4 v31, s[36:39], s57 offen offset:3072  lds
s_mov_b32 m0, 120832
s_add_u32 s57, s57, 8192
buffer_load_dwordx4 v28, s[36:39], s57 offen offset:0  lds
buffer_load_dwordx4 v29, s[36:39], s57 offen offset:1024  lds
s_xor_b32 s3, s16, 0
s_mul_i32 s57, s3, 73728
s_add_u32 s57, s57, s60
s_mov_b32 m0, 0
s_waitcnt vmcnt(36)
s_barrier
buffer_load_dwordx4 v16, s[40:43], s57 offen offset:0  lds
buffer_load_dwordx4 v17, s[40:43], s57 offen offset:1024  lds
buffer_load_dwordx4 v18, s[40:43], s57 offen offset:2048  lds
buffer_load_dwordx4 v19, s[40:43], s57 offen offset:3072  lds
s_mov_b32 m0, 4096
s_nop 0
buffer_load_dwordx4 v72, s[40:43], s57 offen offset:0  lds
buffer_load_dwordx4 v73, s[40:43], s57 offen offset:1024  lds
buffer_load_dwordx4 v74, s[40:43], s57 offen offset:2048  lds
buffer_load_dwordx4 v75, s[40:43], s57 offen offset:3072  lds
s_mov_b32 m0, 8192
s_nop 0
buffer_load_dwordx4 v76, s[40:43], s57 offen offset:0  lds
buffer_load_dwordx4 v77, s[40:43], s57 offen offset:1024  lds
buffer_load_dwordx4 v78, s[40:43], s57 offen offset:2048  lds
buffer_load_dwordx4 v79, s[40:43], s57 offen offset:3072  lds
s_mov_b32 m0, 12288
s_nop 0
buffer_load_dwordx4 v80, s[40:43], s57 offen offset:0  lds
buffer_load_dwordx4 v81, s[40:43], s57 offen offset:1024  lds
buffer_load_dwordx4 v82, s[40:43], s57 offen offset:2048  lds
buffer_load_dwordx4 v83, s[40:43], s57 offen offset:3072  lds
s_xor_b32 s3, s16, 2
s_mul_i32 s57, s3, 73728
s_add_u32 s57, s57, s60
s_mov_b32 m0, 16384
s_waitcnt vmcnt(28)
s_barrier
buffer_load_dwordx4 v16, s[40:43], s57 offen offset:0  lds
buffer_load_dwordx4 v17, s[40:43], s57 offen offset:1024  lds
buffer_load_dwordx4 v18, s[40:43], s57 offen offset:2048  lds
buffer_load_dwordx4 v19, s[40:43], s57 offen offset:3072  lds
s_mov_b32 m0, 20480
s_nop 0
buffer_load_dwordx4 v72, s[40:43], s57 offen offset:0  lds
buffer_load_dwordx4 v73, s[40:43], s57 offen offset:1024  lds
buffer_load_dwordx4 v74, s[40:43], s57 offen offset:2048  lds
buffer_load_dwordx4 v75, s[40:43], s57 offen offset:3072  lds
s_mov_b32 m0, 24576
s_nop 0
buffer_load_dwordx4 v76, s[40:43], s57 offen offset:0  lds
buffer_load_dwordx4 v77, s[40:43], s57 offen offset:1024  lds
buffer_load_dwordx4 v78, s[40:43], s57 offen offset:2048  lds
buffer_load_dwordx4 v79, s[40:43], s57 offen offset:3072  lds
s_mov_b32 m0, 28672
s_nop 0
buffer_load_dwordx4 v80, s[40:43], s57 offen offset:0  lds
buffer_load_dwordx4 v81, s[40:43], s57 offen offset:1024  lds
buffer_load_dwordx4 v82, s[40:43], s57 offen offset:2048  lds
buffer_load_dwordx4 v83, s[40:43], s57 offen offset:3072  lds
s_lshr_b32 s3, s16, 2
s_xor_b32 s3, s3, 0
s_add_u32 s57, s54, s3
s_mul_i32 s57, s57, 12288
s_xor_b32 s3, s16, 1
s_and_b32 s3, s3, 1
s_lshl_b32 s3, s3, 7
s_add_u32 s57, s57, s3
s_mov_b32 m0, 122880
s_nop 0
buffer_load_dwordx4 v28, s[36:39], s57 offen offset:0  lds
buffer_load_dwordx4 v29, s[36:39], s57 offen offset:1024  lds
buffer_load_dwordx4 v30, s[36:39], s57 offen offset:2048  lds
buffer_load_dwordx4 v31, s[36:39], s57 offen offset:3072  lds
s_mov_b32 m0, 126976
s_add_u32 s57, s57, 8192
buffer_load_dwordx4 v28, s[36:39], s57 offen offset:0  lds
buffer_load_dwordx4 v29, s[36:39], s57 offen offset:1024  lds
s_mov_b32 m0, 129024
s_add_u32 s57, s57, 188416
buffer_load_dwordx4 v28, s[36:39], s57 offen offset:0  lds
buffer_load_dwordx4 v29, s[36:39], s57 offen offset:1024  lds
buffer_load_dwordx4 v30, s[36:39], s57 offen offset:2048  lds
buffer_load_dwordx4 v31, s[36:39], s57 offen offset:3072  lds
s_mov_b32 m0, 133120
s_add_u32 s57, s57, 8192
buffer_load_dwordx4 v28, s[36:39], s57 offen offset:0  lds
buffer_load_dwordx4 v29, s[36:39], s57 offen offset:1024  lds
s_xor_b32 s3, s16, 1
s_mul_i32 s57, s3, 73728
s_add_u32 s57, s57, s60
s_mov_b32 m0, 32768
s_nop 0
buffer_load_dwordx4 v16, s[40:43], s57 offen offset:0  lds
buffer_load_dwordx4 v17, s[40:43], s57 offen offset:1024  lds
buffer_load_dwordx4 v18, s[40:43], s57 offen offset:2048  lds
buffer_load_dwordx4 v19, s[40:43], s57 offen offset:3072  lds
s_mov_b32 m0, 36864
s_waitcnt vmcnt(44)
buffer_load_dwordx4 v72, s[40:43], s57 offen offset:0  lds
buffer_load_dwordx4 v73, s[40:43], s57 offen offset:1024  lds
buffer_load_dwordx4 v74, s[40:43], s57 offen offset:2048  lds
buffer_load_dwordx4 v75, s[40:43], s57 offen offset:3072  lds
s_mov_b32 m0, 40960
s_nop 0
buffer_load_dwordx4 v76, s[40:43], s57 offen offset:0  lds
buffer_load_dwordx4 v77, s[40:43], s57 offen offset:1024  lds
buffer_load_dwordx4 v78, s[40:43], s57 offen offset:2048  lds
buffer_load_dwordx4 v79, s[40:43], s57 offen offset:3072  lds
s_mov_b32 m0, 45056
s_nop 0
buffer_load_dwordx4 v80, s[40:43], s57 offen offset:0  lds
buffer_load_dwordx4 v81, s[40:43], s57 offen offset:1024  lds
buffer_load_dwordx4 v82, s[40:43], s57 offen offset:2048  lds
buffer_load_dwordx4 v83, s[40:43], s57 offen offset:3072  lds
s_xor_b32 s3, s16, 3
s_mul_i32 s57, s3, 73728
s_add_u32 s57, s57, s60
s_mov_b32 m0, 73728
s_waitcnt vmcnt(28)
s_barrier
buffer_load_dwordx4 v16, s[40:43], s57 offen offset:0  lds
buffer_load_dwordx4 v17, s[40:43], s57 offen offset:1024  lds
buffer_load_dwordx4 v18, s[40:43], s57 offen offset:2048  lds
buffer_load_dwordx4 v19, s[40:43], s57 offen offset:3072  lds
s_mov_b32 m0, 77824
s_nop 0
buffer_load_dwordx4 v72, s[40:43], s57 offen offset:0  lds
buffer_load_dwordx4 v73, s[40:43], s57 offen offset:1024  lds
buffer_load_dwordx4 v74, s[40:43], s57 offen offset:2048  lds
buffer_load_dwordx4 v75, s[40:43], s57 offen offset:3072  lds
s_mov_b32 m0, 81920
s_nop 0
buffer_load_dwordx4 v76, s[40:43], s57 offen offset:0  lds
buffer_load_dwordx4 v77, s[40:43], s57 offen offset:1024  lds
buffer_load_dwordx4 v78, s[40:43], s57 offen offset:2048  lds
buffer_load_dwordx4 v79, s[40:43], s57 offen offset:3072  lds
s_mov_b32 m0, 86016
s_nop 0
buffer_load_dwordx4 v80, s[40:43], s57 offen offset:0  lds
buffer_load_dwordx4 v81, s[40:43], s57 offen offset:1024  lds
buffer_load_dwordx4 v82, s[40:43], s57 offen offset:2048  lds
buffer_load_dwordx4 v83, s[40:43], s57 offen offset:3072  lds
s_lshr_b32 s3, s16, 2
s_xor_b32 s3, s3, 1
s_add_u32 s57, s54, s3
s_mul_i32 s57, s57, 12288
s_xor_b32 s3, s16, 0
s_and_b32 s3, s3, 1
s_lshl_b32 s3, s3, 7
s_add_u32 s57, s57, s3
s_mov_b32 m0, 135168
s_nop 0
buffer_load_dwordx4 v28, s[36:39], s57 offen offset:0  lds
buffer_load_dwordx4 v29, s[36:39], s57 offen offset:1024  lds
buffer_load_dwordx4 v30, s[36:39], s57 offen offset:2048  lds
buffer_load_dwordx4 v31, s[36:39], s57 offen offset:3072  lds
s_mov_b32 m0, 139264
s_add_u32 s57, s57, 8192
buffer_load_dwordx4 v28, s[36:39], s57 offen offset:0  lds
buffer_load_dwordx4 v29, s[36:39], s57 offen offset:1024  lds
s_mov_b32 m0, 141312
s_add_u32 s57, s57, 188416
buffer_load_dwordx4 v28, s[36:39], s57 offen offset:0  lds
buffer_load_dwordx4 v29, s[36:39], s57 offen offset:1024  lds
buffer_load_dwordx4 v30, s[36:39], s57 offen offset:2048  lds
buffer_load_dwordx4 v31, s[36:39], s57 offen offset:3072  lds
s_mov_b32 m0, 145408
s_add_u32 s57, s57, 8192
buffer_load_dwordx4 v28, s[36:39], s57 offen offset:0  lds
buffer_load_dwordx4 v29, s[36:39], s57 offen offset:1024  lds
s_xor_b32 s3, s16, 4
s_mul_i32 s57, s3, 73728
s_add_u32 s57, s57, s60
s_mov_b32 m0, 49152
s_nop 0
buffer_load_dwordx4 v16, s[40:43], s57 offen offset:0  lds
buffer_load_dwordx4 v17, s[40:43], s57 offen offset:1024  lds
buffer_load_dwordx4 v18, s[40:43], s57 offen offset:2048  lds
buffer_load_dwordx4 v19, s[40:43], s57 offen offset:3072  lds
s_mov_b32 m0, 53248
s_waitcnt vmcnt(44)
buffer_load_dwordx4 v72, s[40:43], s57 offen offset:0  lds
buffer_load_dwordx4 v73, s[40:43], s57 offen offset:1024  lds
buffer_load_dwordx4 v74, s[40:43], s57 offen offset:2048  lds
buffer_load_dwordx4 v75, s[40:43], s57 offen offset:3072  lds
s_mov_b32 m0, 57344
s_nop 0
buffer_load_dwordx4 v76, s[40:43], s57 offen offset:0  lds
buffer_load_dwordx4 v77, s[40:43], s57 offen offset:1024  lds
buffer_load_dwordx4 v78, s[40:43], s57 offen offset:2048  lds
buffer_load_dwordx4 v79, s[40:43], s57 offen offset:3072  lds
s_mov_b32 m0, 61440
s_nop 0
buffer_load_dwordx4 v80, s[40:43], s57 offen offset:0  lds
buffer_load_dwordx4 v81, s[40:43], s57 offen offset:1024  lds
buffer_load_dwordx4 v82, s[40:43], s57 offen offset:2048  lds
buffer_load_dwordx4 v83, s[40:43], s57 offen offset:3072  lds
s_xor_b32 s3, s16, 6
s_mul_i32 s57, s3, 73728
s_add_u32 s57, s57, s60
s_mov_b32 m0, 0
s_waitcnt vmcnt(44)
s_barrier
buffer_load_dwordx4 v16, s[40:43], s57 offen offset:0  lds
buffer_load_dwordx4 v17, s[40:43], s57 offen offset:1024  lds
buffer_load_dwordx4 v18, s[40:43], s57 offen offset:2048  lds
buffer_load_dwordx4 v19, s[40:43], s57 offen offset:3072  lds
s_mov_b32 m0, 4096
s_nop 0
buffer_load_dwordx4 v72, s[40:43], s57 offen offset:0  lds
buffer_load_dwordx4 v73, s[40:43], s57 offen offset:1024  lds
buffer_load_dwordx4 v74, s[40:43], s57 offen offset:2048  lds
buffer_load_dwordx4 v75, s[40:43], s57 offen offset:3072  lds
s_mov_b32 m0, 8192
s_nop 0
buffer_load_dwordx4 v76, s[40:43], s57 offen offset:0  lds
buffer_load_dwordx4 v77, s[40:43], s57 offen offset:1024  lds
buffer_load_dwordx4 v78, s[40:43], s57 offen offset:2048  lds
buffer_load_dwordx4 v79, s[40:43], s57 offen offset:3072  lds
s_mov_b32 m0, 12288
s_nop 0
buffer_load_dwordx4 v80, s[40:43], s57 offen offset:0  lds
buffer_load_dwordx4 v81, s[40:43], s57 offen offset:1024  lds
buffer_load_dwordx4 v82, s[40:43], s57 offen offset:2048  lds
buffer_load_dwordx4 v83, s[40:43], s57 offen offset:3072  lds
s_lshr_b32 s3, s16, 2
s_xor_b32 s3, s3, 1
s_add_u32 s57, s54, s3
s_mul_i32 s57, s57, 12288
s_xor_b32 s3, s16, 1
s_and_b32 s3, s3, 1
s_lshl_b32 s3, s3, 7
s_add_u32 s57, s57, s3
s_mov_b32 m0, 147456
s_waitcnt vmcnt(44)
s_barrier
buffer_load_dwordx4 v28, s[36:39], s57 offen offset:0  lds
buffer_load_dwordx4 v29, s[36:39], s57 offen offset:1024  lds
buffer_load_dwordx4 v30, s[36:39], s57 offen offset:2048  lds
buffer_load_dwordx4 v31, s[36:39], s57 offen offset:3072  lds
s_mov_b32 m0, 151552
s_add_u32 s57, s57, 8192
buffer_load_dwordx4 v28, s[36:39], s57 offen offset:0  lds
buffer_load_dwordx4 v29, s[36:39], s57 offen offset:1024  lds
s_mov_b32 m0, 153600
s_add_u32 s57, s57, 188416
buffer_load_dwordx4 v28, s[36:39], s57 offen offset:0  lds
buffer_load_dwordx4 v29, s[36:39], s57 offen offset:1024  lds
buffer_load_dwordx4 v30, s[36:39], s57 offen offset:2048  lds
buffer_load_dwordx4 v31, s[36:39], s57 offen offset:3072  lds
s_mov_b32 m0, 157696
s_add_u32 s57, s57, 8192
buffer_load_dwordx4 v28, s[36:39], s57 offen offset:0  lds
buffer_load_dwordx4 v29, s[36:39], s57 offen offset:1024  lds
s_xor_b32 s3, s16, 5
s_mul_i32 s57, s3, 73728
s_add_u32 s57, s57, s60
s_mov_b32 m0, 16384
s_nop 0
buffer_load_dwordx4 v16, s[40:43], s57 offen offset:0  lds
buffer_load_dwordx4 v17, s[40:43], s57 offen offset:1024  lds
buffer_load_dwordx4 v18, s[40:43], s57 offen offset:2048  lds
buffer_load_dwordx4 v19, s[40:43], s57 offen offset:3072  lds
s_mov_b32 m0, 20480
s_waitcnt vmcnt(44)
buffer_load_dwordx4 v72, s[40:43], s57 offen offset:0  lds
buffer_load_dwordx4 v73, s[40:43], s57 offen offset:1024  lds
buffer_load_dwordx4 v74, s[40:43], s57 offen offset:2048  lds
buffer_load_dwordx4 v75, s[40:43], s57 offen offset:3072  lds
s_mov_b32 m0, 24576
s_nop 0
buffer_load_dwordx4 v76, s[40:43], s57 offen offset:0  lds
buffer_load_dwordx4 v77, s[40:43], s57 offen offset:1024  lds
buffer_load_dwordx4 v78, s[40:43], s57 offen offset:2048  lds
buffer_load_dwordx4 v79, s[40:43], s57 offen offset:3072  lds
s_mov_b32 m0, 28672
s_nop 0
buffer_load_dwordx4 v80, s[40:43], s57 offen offset:0  lds
buffer_load_dwordx4 v81, s[40:43], s57 offen offset:1024  lds
buffer_load_dwordx4 v82, s[40:43], s57 offen offset:2048  lds
buffer_load_dwordx4 v83, s[40:43], s57 offen offset:3072  lds
s_xor_b32 s3, s16, 7
s_mul_i32 s57, s3, 73728
s_add_u32 s57, s57, s60
s_mov_b32 m0, 32768
s_waitcnt vmcnt(44)
s_barrier
buffer_load_dwordx4 v16, s[40:43], s57 offen offset:0  lds
buffer_load_dwordx4 v17, s[40:43], s57 offen offset:1024  lds
buffer_load_dwordx4 v18, s[40:43], s57 offen offset:2048  lds
buffer_load_dwordx4 v19, s[40:43], s57 offen offset:3072  lds
s_mov_b32 m0, 36864
s_nop 0
buffer_load_dwordx4 v72, s[40:43], s57 offen offset:0  lds
buffer_load_dwordx4 v73, s[40:43], s57 offen offset:1024  lds
buffer_load_dwordx4 v74, s[40:43], s57 offen offset:2048  lds
buffer_load_dwordx4 v75, s[40:43], s57 offen offset:3072  lds
s_mov_b32 m0, 40960
s_nop 0
buffer_load_dwordx4 v76, s[40:43], s57 offen offset:0  lds
buffer_load_dwordx4 v77, s[40:43], s57 offen offset:1024  lds
buffer_load_dwordx4 v78, s[40:43], s57 offen offset:2048  lds
buffer_load_dwordx4 v79, s[40:43], s57 offen offset:3072  lds
s_mov_b32 m0, 45056
s_nop 0
buffer_load_dwordx4 v80, s[40:43], s57 offen offset:0  lds
buffer_load_dwordx4 v81, s[40:43], s57 offen offset:1024  lds
buffer_load_dwordx4 v82, s[40:43], s57 offen offset:2048  lds
buffer_load_dwordx4 v83, s[40:43], s57 offen offset:3072  lds
s_waitcnt vmcnt(44)
s_barrier
s_waitcnt vmcnt(16)
s_barrier
s_xor_b32 s3, s59, 0
s_mul_i32 s57, s3, 73728
s_add_u32 s57, s57, s62
s_mov_b32 m0, 49152
s_waitcnt vmcnt(0)
s_barrier
buffer_load_dwordx4 v24, s[40:43], s57 offen offset:0  lds
buffer_load_dwordx4 v25, s[40:43], s57 offen offset:1024  lds
buffer_load_dwordx4 v26, s[40:43], s57 offen offset:2048  lds
buffer_load_dwordx4 v27, s[40:43], s57 offen offset:3072  lds
s_mov_b32 m0, 53248
s_add_u32 s57, s57, 36864
buffer_load_dwordx4 v24, s[40:43], s57 offen offset:0  lds
buffer_load_dwordx4 v25, s[40:43], s57 offen offset:1024  lds
buffer_load_dwordx4 v26, s[40:43], s57 offen offset:2048  lds
buffer_load_dwordx4 v27, s[40:43], s57 offen offset:3072  lds
s_xor_b32 s3, s59, 1
s_mul_i32 s57, s3, 73728
s_add_u32 s57, s57, s62
s_mov_b32 m0, 57344
s_nop 0
buffer_load_dwordx4 v24, s[40:43], s57 offen offset:0  lds
buffer_load_dwordx4 v25, s[40:43], s57 offen offset:1024  lds
buffer_load_dwordx4 v26, s[40:43], s57 offen offset:2048  lds
buffer_load_dwordx4 v27, s[40:43], s57 offen offset:3072  lds
s_mov_b32 m0, 61440
s_add_u32 s57, s57, 36864
buffer_load_dwordx4 v24, s[40:43], s57 offen offset:0  lds
buffer_load_dwordx4 v25, s[40:43], s57 offen offset:1024  lds
buffer_load_dwordx4 v26, s[40:43], s57 offen offset:2048  lds
buffer_load_dwordx4 v27, s[40:43], s57 offen offset:3072  lds
s_xor_b32 s3, s59, 2
s_mul_i32 s57, s3, 73728
s_add_u32 s57, s57, s62
s_mov_b32 m0, 0
s_barrier
buffer_load_dwordx4 v24, s[40:43], s57 offen offset:0  lds
buffer_load_dwordx4 v25, s[40:43], s57 offen offset:1024  lds
buffer_load_dwordx4 v26, s[40:43], s57 offen offset:2048  lds
buffer_load_dwordx4 v27, s[40:43], s57 offen offset:3072  lds
s_mov_b32 m0, 4096
s_add_u32 s57, s57, 36864
buffer_load_dwordx4 v24, s[40:43], s57 offen offset:0  lds
buffer_load_dwordx4 v25, s[40:43], s57 offen offset:1024  lds
buffer_load_dwordx4 v26, s[40:43], s57 offen offset:2048  lds
buffer_load_dwordx4 v27, s[40:43], s57 offen offset:3072  lds
s_xor_b32 s3, s59, 3
s_mul_i32 s57, s3, 73728
s_add_u32 s57, s57, s62
s_mov_b32 m0, 8192
s_nop 0
buffer_load_dwordx4 v24, s[40:43], s57 offen offset:0  lds
buffer_load_dwordx4 v25, s[40:43], s57 offen offset:1024  lds
buffer_load_dwordx4 v26, s[40:43], s57 offen offset:2048  lds
buffer_load_dwordx4 v27, s[40:43], s57 offen offset:3072  lds
s_mov_b32 m0, 12288
s_add_u32 s57, s57, 36864
buffer_load_dwordx4 v24, s[40:43], s57 offen offset:0  lds
buffer_load_dwordx4 v25, s[40:43], s57 offen offset:1024  lds
buffer_load_dwordx4 v26, s[40:43], s57 offen offset:2048  lds
buffer_load_dwordx4 v27, s[40:43], s57 offen offset:3072  lds
s_waitcnt vmcnt(0)
s_barrier
s_mov_b32 s48, s10
s_mov_b32 s49, s11
s_mov_b32 s50, 884736
s_mov_b32 s51, 0x20000
s_lshl_b32 s52, s21, 1
s_lshr_b32 s3, s22, 1
s_add_u32 s52, s52, s3
s_cmp_ge_u32 s52, 12
s_cbranch_scc1 L_end
s_lshl_b32 s3, s2, 9
s_add_u32 s62, s3, 384
s_add_u32 s66, s14, s62
s_addc_u32 s67, s15, 0
s_mov_b32 s54, 65536
s_lshl_b32 s3, s23, 1
s_and_b32 s53, s22, 1
s_add_u32 s53, s53, s3
s_mul_i32 s55, s53, 12
s_add_u32 s55, s55, s52
s_mul_i32 s55, s55, 8192
s_add_u32 s55, s55, 13631488
s_add_u32 s56, s55, 4096
s_cmp_ge_u32 s52, 6
s_cselect_b32 s58, 55232, 0
s_mul_i32 s57, s53, 6
s_add_u32 s57, s57, s52
s_mul_i32 s57, s57, 9216
s_sub_u32 s57, s57, s58
s_add_u32 s57, s57, 1024
v_lshlrev_b32 v6, 4, v0
v_and_b32 v4, 3, v0
v_lshrrev_b32 v5, 5, v0
v_lshl_add_u32 v4, v4, 1, v5
v_bfe_u32 v5, v0, 2, 3
v_mul_u32_u24 v3, 1152, v4
v_lshl_add_u32 v3, v5, 3, v3
s_mov_b32 s29, 0xffff0000
L_op:
s_load_dword s84, s[66:67], 0 glc
s_sub_u32 s54, s54, 1
s_cbranch_scc1 L_opok
s_waitcnt lgkmcnt(0)
s_cmp_lt_u32 s84, 32
s_cbranch_scc1 L_op
L_opok:
s_mov_b32 s63, 0
L_again:
buffer_load_dwordx4 v[32:35], v6, s[44:47], s55 offen offset:0 sc1
buffer_load_dwordx4 v[36:39], v6, s[44:47], s55 offen offset:1024 sc1
buffer_load_dwordx4 v[40:43], v6, s[44:47], s55 offen offset:2048 sc1
buffer_load_dwordx4 v[44:47], v6, s[44:47], s55 offen offset:3072 sc1
buffer_load_dwordx4 v[48:51], v6, s[44:47], s56 offen offset:0 sc1
buffer_load_dwordx4 v[52:55], v6, s[44:47], s56 offen offset:1024 sc1
buffer_load_dwordx4 v[56:59], v6, s[44:47], s56 offen offset:2048 sc1
buffer_load_dwordx4 v[60:63], v6, s[44:47], s56 offen offset:3072 sc1
L_dry_op:
s_waitcnt vmcnt(7)
v_lshlrev_b32 v8, 16, v32
v_lshlrev_b32 v9, 16, v33
v_lshlrev_b32 v10, 16, v34
v_lshlrev_b32 v11, 16, v35
v_and_b32 v12, s29, v32
v_and_b32 v13, s29, v33
v_and_b32 v14, s29, v34
v_and_b32 v15, s29, v35
s_waitcnt vmcnt(6)
v_lshlrev_b32 v20, 16, v36
v_lshlrev_b32 v21, 16, v37
v_lshlrev_b32 v22, 16, v38
v_lshlrev_b32 v23, 16, v39
v_and_b32 v36, s29, v36
v_and_b32 v37, s29, v37
v_and_b32 v38, s29, v38
v_and_b32 v39, s29, v39
v_pk_add_f32 v[8:9], v[8:9], v[20:21]
v_pk_add_f32 v[10:11], v[10:11], v[22:23]
v_pk_add_f32 v[12:13], v[12:13], v[36:37]
v_pk_add_f32 v[14:15], v[14:15], v[38:39]
s_waitcnt vmcnt(5)
v_lshlrev_b32 v16, 16, v40
v_lshlrev_b32 v17, 16, v41
v_lshlrev_b32 v18, 16, v42
v_lshlrev_b32 v19, 16, v43
v_and_b32 v40, s29, v40
v_and_b32 v41, s29, v41
v_and_b32 v42, s29, v42
v_and_b32 v43, s29, v43
v_pk_add_f32 v[8:9], v[8:9], v[16:17]
v_pk_add_f32 v[10:11], v[10:11], v[18:19]
v_pk_add_f32 v[12:13], v[12:13], v[40:41]
v_pk_add_f32 v[14:15], v[14:15], v[42:43]
s_waitcnt vmcnt(4)
v_lshlrev_b32 v20, 16, v44
v_lshlrev_b32 v21, 16, v45
v_lshlrev_b32 v22, 16, v46
v_lshlrev_b32 v23, 16, v47
v_and_b32 v44, s29, v44
v_and_b32 v45, s29, v45
v_and_b32 v46, s29, v46
v_and_b32 v47, s29, v47
v_pk_add_f32 v[8:9], v[8:9], v[20:21]
v_pk_add_f32 v[10:11], v[10:11], v[22:23]
v_pk_add_f32 v[12:13], v[12:13], v[44:45]
v_pk_add_f32 v[14:15], v[14:15], v[46:47]
s_waitcnt vmcnt(3)
v_lshlrev_b32 v16, 16, v48
v_lshlrev_b32 v17, 16, v49
v_lshlrev_b32 v18, 16, v50
v_lshlrev_b32 v19, 16, v51
v_and_b32 v48, s29, v48
v_and_b32 v49, s29, v49
v_and_b32 v50, s29, v50
v_and_b32 v51, s29, v51
v_pk_add_f32 v[8:9], v[8:9], v[16:17]
v_pk_add_f32 v[10:11], v[10:11], v[18:19]
v_pk_add_f32 v[12:13], v[12:13], v[48:49]
v_pk_add_f32 v[14:15], v[14:15], v[50:51]
s_waitcnt vmcnt(2)
v_lshlrev_b32 v20, 16, v52
v_lshlrev_b32 v21, 16, v53
v_lshlrev_b32 v22, 16, v54
v_lshlrev_b32 v23, 16, v55
v_and_b32 v52, s29, v52
v_and_b32 v53, s29, v53
v_and_b32 v54, s29, v54
v_and_b32 v55, s29, v55
v_pk_add_f32 v[8:9], v[8:9], v[20:21]
v_pk_add_f32 v[10:11], v[10:11], v[22:23]
v_pk_add_f32 v[12:13], v[12:13], v[52:53]
v_pk_add_f32 v[14:15], v[14:15], v[54:55]
s_waitcnt vmcnt(1)
v_lshlrev_b32 v16, 16, v56
v_lshlrev_b32 v17, 16, v57
v_lshlrev_b32 v18, 16, v58
v_lshlrev_b32 v19, 16, v59
v_and_b32 v56, s29, v56
v_and_b32 v57, s29, v57
v_and_b32 v58, s29, v58
v_and_b32 v59, s29, v59
v_pk_add_f32 v[8:9], v[8:9], v[16:17]
v_pk_add_f32 v[10:11], v[10:11], v[18:19]
v_pk_add_f32 v[12:13], v[12:13], v[56:57]
v_pk_add_f32 v[14:15], v[14:15], v[58:59]
s_waitcnt vmcnt(0)
v_lshlrev_b32 v20, 16, v60
v_lshlrev_b32 v21, 16, v61
v_lshlrev_b32 v22, 16, v62
v_lshlrev_b32 v23, 16, v63
v_and_b32 v60, s29, v60
v_and_b32 v61, s29, v61
v_and_b32 v62, s29, v62
v_and_b32 v63, s29, v63
v_pk_add_f32 v[8:9], v[8:9], v[20:21]
v_pk_add_f32 v[10:11], v[10:11], v[22:23]
v_pk_add_f32 v[12:13], v[12:13], v[60:61]
v_pk_add_f32 v[14:15], v[14:15], v[62:63]
v_permlane32_swap_b32 v8, v10
v_permlane32_swap_b32 v9, v11
v_permlane32_swap_b32 v12, v14
v_permlane32_swap_b32 v13, v15
v_pk_add_f32 v[8:9], v[8:9], v[10:11]
v_pk_add_f32 v[12:13], v[12:13], v[14:15]
v_cmp_u_f32 vcc, v8, v9
s_cbranch_vccnz L_retry
L_accept:
v_cvt_pk_bf16_f32 v8, v8, v12
v_cvt_pk_bf16_f32 v9, v9, v13
s_cbranch_execz L_dryret_op
buffer_store_dwordx2 v[8:9], v3, s[48:51], s57 offen offset:0 sc1
s_endpgm
L_retry:
s_cmp_lg_u32 s63, 0
s_cbranch_scc1 L_accept
s_mov_b32 s63, 1
s_mov_b32 s54, 65536
s_cmp_ge_u32 s52, 6
s_cselect_b32 s3, 3, 0
s_and_b32 s62, s2, 0xe8
s_or_b32 s3, s3, s62
s_lshl_b32 s3, s3, 9
s_add_u32 s62, s3, 384
s_add_u32 s66, s14, s62
s_addc_u32 s67, s15, 0
L_oq:
s_load_dword s84, s[66:67], 64 glc
s_sub_u32 s54, s54, 1
s_cbranch_scc1 L_oqok
s_waitcnt lgkmcnt(0)
s_cmp_lt_u32 s84, 32
s_cbranch_scc1 L_oq
L_oqok:
s_branch L_again
L_comp:
v_bfe_u32 v3, v0, 2, 2
v_and_b32 v4, 3, v0
s_lshr_b32 s18, s20, 1
s_and_b32 s17, s20, 1
s_and_b32 s16, s22, 1
s_xor_b32 s16, s16, s23
s_and_b32 s16, s16, 3
v_lshrrev_b32 v7, 1, v1
v_xor_b32 v7, v7, v2
v_lshlrev_b32 v7, 4, v7
v_lshl_add_u32 v5, v1, 7, v7
v_xor_b32 v6, 64, v5
s_mul_i32 s3, s18, 6144
s_add_u32 s3, s3, 49152
v_add_u32 v10, s3, v5
v_add_u32 v11, s3, v6
s_add_u32 s3, s3, 61440
v_add_u32 v16, s3, v5
v_add_u32 v17, s3, v6
s_and_b32 s3, s22, 1
s_mul_i32 s3, s3, 6144
s_add_u32 s3, s3, 110592
s_and_b32 s19, s22, 2
s_mul_i32 s19, s19, 12288
s_add_u32 s3, s3, s19
v_add_u32 v18, s3, v5
v_add_u32 v19, s3, v6
v_and_b32 v7, 1, v2
v_lshl_add_u32 v7, v7, 2, v3
s_lshl_b32 s3, s17, 2
v_xor_b32 v7, s3, v7
v_lshl_add_u32 v5, v2, 3, v3
v_lshlrev_b32 v8, 8, v5
v_lshl_add_u32 v8, v4, 3, v8
v_xor_b32 v9, 0, v7
v_lshl_add_u32 v12, v9, 5, v8
v_xor_b32 v9, 1, v7
v_lshl_add_u32 v13, v9, 5, v8
v_xor_b32 v9, 2, v7
v_lshl_add_u32 v14, v9, 5, v8
v_xor_b32 v9, 3, v7
v_lshl_add_u32 v15, v9, 5, v8
v_and_b32 v7, 1, v2
v_lshrrev_b32 v8, 1, v3
v_lshl_add_u32 v7, v7, 1, v8
v_xor_b32 v7, s20, v7
v_lshlrev_b32 v8, 7, v5
v_lshl_add_u32 v8, v4, 3, v8
v_lshl_add_u32 v20, v7, 5, v8
s_mul_i32 s3, s18, 12288
s_lshl_b32 s19, s17, 11
s_add_u32 s3, s3, s19
s_add_u32 s3, s3, 49152
v_lshlrev_b32 v25, 4, v0
v_lshlrev_b32 v26, 3, v0
v_add_u32 v21, s3, v26
v_lshrrev_b32 v7, 1, v2
v_lshl_add_u32 v7, v7, 4, v1
v_lshlrev_b32 v7, 4, v7
v_and_b32 v8, 1, v2
v_lshl_add_u32 v7, v8, 3, v7
v_add_u32 v21, s3, v7
s_and_b32 s59, s2, 0xf8
s_lshl_b32 s48, s20, 1
s_add_u32 s59, s59, s48
s_and_b32 s3, s2, 1
s_add_u32 s3, s3, s59
s_mul_i32 s34, s3, 21504
s_xor_b32 s3, s3, 1
s_mul_i32 s35, s3, 21504
s_and_b32 s3, s21, 6
s_xor_b32 s48, s48, s3
s_lshl_b32 s3, s48, 10
s_add_u32 s3, s3, 4194304
s_add_u32 s34, s34, s3
s_add_u32 s35, s35, s3
s_add_u32 s35, s35, 1024
s_cmp_eq_u32 s48, 0
s_cselect_b32 s33, 0x7ff00000, 0
s_cselect_b64 s[30:31], -1, 0
v_add_u32 v27, 159744, v25
s_add_u32 s36, s34, 7168
s_add_u32 s37, s35, 7168
s_add_u32 s38, s34, 14336
s_add_u32 s39, s35, 14336
s_lshl_b32 s3, s23, 1
s_and_b32 s54, s22, 1
s_add_u32 s3, s3, s54
s_mul_i32 s3, s3, 12
s_mul_i32 s54, s18, 6
s_add_u32 s3, s3, s54
s_mul_i32 s58, s3, 8192
s_lshl_b32 s3, s17, 8
s_add_u32 s58, s58, s3
s_lshl_b32 s3, s21, 1
s_lshr_b32 s55, s22, 1
s_add_u32 s55, s55, s3
s_lshl_b32 s3, s55, 9
s_add_u32 s58, s58, s3
s_add_u32 s58, s58, 13631488
v_and_b32 v5, 7, v0
v_lshrrev_b32 v6, 3, v0
v_add_u32 v7, s59, v5
v_lshlrev_b32 v7, 9, v7
s_mov_b32 s3, 64
v_add_u32 v7, s3, v7
s_sub_u32 s54, s54, 2
v_add_u32 v8, s54, v5
v_lshrrev_b32 v9, 1, v8
v_and_b32 v8, 1, v8
v_lshl_add_u32 v8, v8, 4, v9
s_and_b32 s3, s2, 0xe8
v_add_u32 v8, s3, v8
v_lshlrev_b32 v8, 9, v8
s_mov_b32 s3, 128
v_add_u32 v8, s3, v8
v_mov_b32 v9, 0x7ff00000
v_lshl_add_u32 v7, v6, 6, v7
v_lshl_add_u32 v8, v6, 6, v8
v_cmp_gt_u32 vcc, 1, v6
s_nop 1
v_cndmask_b32 v5, 8, v5, vcc
v_cmp_gt_u32 vcc, 8, v5
s_nop 1
v_cndmask_b32 v8, v9, v8, vcc
v_cmp_gt_u32 vcc, 2, v5
s_nop 1
v_cndmask_b32 v30, v8, v7, vcc
v_cndmask_b32 v28, v9, v7, vcc
v_mov_b32 v29, 1
v_cmp_gt_u32 vcc, 1, v5
s_nop 1
v_cndmask_b32 v28, v9, v7, vcc
s_add_u32 s56, s58, 16384
s_add_u32 s57, s58, 32768
v_lshrrev_b32 v7, 3, v1
v_mul_u32_u24 v7, 8192, v7
v_lshl_add_u32 v7, v2, 6, v7
v_and_b32 v8, 7, v0
v_lshl_add_u32 v3, v8, 3, v7
s_mov_b32 s52, s20
s_cmp_ge_u32 s52, 3
s_cselect_b32 s3, 12288, 0
s_add_u32 s3, s3, 73728
v_xor_b32 v7, v1, v2
v_lshlrev_b32 v7, 4, v7
v_lshl_add_u32 v7, v1, 8, v7
v_xor_b32 v8, 0, v7
v_add_u32 v184, s3, v8
v_xor_b32 v8, 64, v7
v_add_u32 v185, s3, v8
v_xor_b32 v8, 128, v7
v_add_u32 v186, s3, v8
v_xor_b32 v8, 192, v7
v_add_u32 v187, s3, v8
s_lshl_b32 s3, s52, 12
s_add_u32 s3, s3, 49152
v_add_u32 v254, s3, v25
s_mov_b32 s50, 0x3e0293ee
s_mov_b32 s51, s50
s_mul_i32 s3, s52, 1536
s_mul_i32 s49, s2, 9216
s_add_u32 s49, s49, s3
s_add_u32 s49, s49, 262144
s_add_u32 s3, s3, 101376
v_add_u32 v255, s3, v25
v_add_u32 v31, s3, v26
v_add_u32 v1, s33, v25
s_waitcnt lgkmcnt(0)
s_mov_b32 s44, s14
s_mov_b32 s45, s15
s_mov_b32 s46, 268435456
s_mov_b32 s47, 0x20000
s_barrier
ds_read_b128 v[96:99], v10 offset:49152
ds_read_b128 v[100:103], v10 offset:51200
ds_read_b128 v[104:107], v10 offset:53248
ds_read_b64_tr_b16 v[80:81], v12 offset:0
ds_read_b64_tr_b16 v[82:83], v12 offset:1024
ds_read_b64_tr_b16 v[84:85], v13 offset:0
ds_read_b64_tr_b16 v[86:87], v13 offset:1024
ds_read_b64_tr_b16 v[88:89], v14 offset:0
ds_read_b64_tr_b16 v[90:91], v14 offset:1024
ds_read_b64_tr_b16 v[92:93], v15 offset:0
ds_read_b64_tr_b16 v[94:95], v15 offset:1024
s_waitcnt lgkmcnt(0)
v_mfma_f32_16x16x32_bf16 v[32:35], v[80:83], v[96:99], 0
ds_read_b128 v[124:127], v11 offset:49152
ds_read_b128 v[128:131], v11 offset:51200
v_mfma_f32_16x16x32_bf16 v[36:39], v[80:83], v[100:103], 0
ds_read_b128 v[132:135], v11 offset:53248
ds_read_b64_tr_b16 v[108:109], v12 offset:8192
v_mfma_f32_16x16x32_bf16 v[40:43], v[80:83], v[104:107], 0
ds_read_b64_tr_b16 v[110:111], v12 offset:9216
ds_read_b64_tr_b16 v[112:113], v13 offset:8192
v_mfma_f32_16x16x32_bf16 v[52:55], v[84:87], v[104:107], 0
ds_read_b64_tr_b16 v[114:115], v13 offset:9216
ds_read_b64_tr_b16 v[116:117], v14 offset:8192
v_mfma_f32_16x16x32_bf16 v[48:51], v[84:87], v[100:103], 0
ds_read_b64_tr_b16 v[118:119], v14 offset:9216
ds_read_b64_tr_b16 v[120:121], v15 offset:8192
v_mfma_f32_16x16x32_bf16 v[44:47], v[84:87], v[96:99], 0
ds_read_b64_tr_b16 v[122:123], v15 offset:9216
v_mfma_f32_16x16x32_bf16 v[56:59], v[88:91], v[96:99], 0
v_mfma_f32_16x16x32_bf16 v[60:63], v[88:91], v[100:103], 0
v_mfma_f32_16x16x32_bf16 v[64:67], v[88:91], v[104:107], 0
v_mfma_f32_16x16x32_bf16 v[76:79], v[92:95], v[104:107], 0
v_mfma_f32_16x16x32_bf16 v[72:75], v[92:95], v[100:103], 0
v_mfma_f32_16x16x32_bf16 v[68:71], v[92:95], v[96:99], 0
s_waitcnt lgkmcnt(0)
s_barrier
v_mfma_f32_16x16x32_bf16 v[32:35], v[108:111], v[124:127], v[32:35]
ds_read_b128 v[96:99], v10 offset:24576
ds_read_b128 v[100:103], v10 offset:26624
v_mfma_f32_16x16x32_bf16 v[36:39], v[108:111], v[128:131], v[36:39]
ds_read_b128 v[104:107], v10 offset:28672
ds_read_b64_tr_b16 v[80:81], v12 offset:16384
v_mfma_f32_16x16x32_bf16 v[40:43], v[108:111], v[132:135], v[40:43]
ds_read_b64_tr_b16 v[82:83], v12 offset:17408
ds_read_b64_tr_b16 v[84:85], v13 offset:16384
v_mfma_f32_16x16x32_bf16 v[52:55], v[112:115], v[132:135], v[52:55]
ds_read_b64_tr_b16 v[86:87], v13 offset:17408
ds_read_b64_tr_b16 v[88:89], v14 offset:16384
v_mfma_f32_16x16x32_bf16 v[48:51], v[112:115], v[128:131], v[48:51]
ds_read_b64_tr_b16 v[90:91], v14 offset:17408
ds_read_b64_tr_b16 v[92:93], v15 offset:16384
v_mfma_f32_16x16x32_bf16 v[44:47], v[112:115], v[124:127], v[44:47]
ds_read_b64_tr_b16 v[94:95], v15 offset:17408
v_mfma_f32_16x16x32_bf16 v[56:59], v[116:119], v[124:127], v[56:59]
v_mfma_f32_16x16x32_bf16 v[60:63], v[116:119], v[128:131], v[60:63]
v_mfma_f32_16x16x32_bf16 v[64:67], v[116:119], v[132:135], v[64:67]
v_mfma_f32_16x16x32_bf16 v[76:79], v[120:123], v[132:135], v[76:79]
v_mfma_f32_16x16x32_bf16 v[72:75], v[120:123], v[128:131], v[72:75]
v_mfma_f32_16x16x32_bf16 v[68:71], v[120:123], v[124:127], v[68:71]
s_waitcnt lgkmcnt(0)
v_mfma_f32_16x16x32_bf16 v[32:35], v[80:83], v[96:99], v[32:35]
ds_read_b128 v[124:127], v11 offset:24576
ds_read_b128 v[128:131], v11 offset:26624
v_mfma_f32_16x16x32_bf16 v[36:39], v[80:83], v[100:103], v[36:39]
ds_read_b128 v[132:135], v11 offset:28672
ds_read_b64_tr_b16 v[108:109], v12 offset:24576
v_mfma_f32_16x16x32_bf16 v[40:43], v[80:83], v[104:107], v[40:43]
ds_read_b64_tr_b16 v[110:111], v12 offset:25600
ds_read_b64_tr_b16 v[112:113], v13 offset:24576
v_mfma_f32_16x16x32_bf16 v[52:55], v[84:87], v[104:107], v[52:55]
ds_read_b64_tr_b16 v[114:115], v13 offset:25600
ds_read_b64_tr_b16 v[116:117], v14 offset:24576
v_mfma_f32_16x16x32_bf16 v[48:51], v[84:87], v[100:103], v[48:51]
ds_read_b64_tr_b16 v[118:119], v14 offset:25600
ds_read_b64_tr_b16 v[120:121], v15 offset:24576
v_mfma_f32_16x16x32_bf16 v[44:47], v[84:87], v[96:99], v[44:47]
ds_read_b64_tr_b16 v[122:123], v15 offset:25600
v_mfma_f32_16x16x32_bf16 v[56:59], v[88:91], v[96:99], v[56:59]
v_mfma_f32_16x16x32_bf16 v[60:63], v[88:91], v[100:103], v[60:63]
v_mfma_f32_16x16x32_bf16 v[64:67], v[88:91], v[104:107], v[64:67]
v_mfma_f32_16x16x32_bf16 v[76:79], v[92:95], v[104:107], v[76:79]
v_mfma_f32_16x16x32_bf16 v[72:75], v[92:95], v[100:103], v[72:75]
v_mfma_f32_16x16x32_bf16 v[68:71], v[92:95], v[96:99], v[68:71]
s_waitcnt lgkmcnt(0)
s_barrier
v_mfma_f32_16x16x32_bf16 v[32:35], v[108:111], v[124:127], v[32:35]
ds_read_b128 v[96:99], v10 offset:0
ds_read_b128 v[100:103], v10 offset:2048
v_mfma_f32_16x16x32_bf16 v[36:39], v[108:111], v[128:131], v[36:39]
ds_read_b128 v[104:107], v10 offset:4096
ds_read_b64_tr_b16 v[80:81], v12 offset:32768
v_mfma_f32_16x16x32_bf16 v[40:43], v[108:111], v[132:135], v[40:43]
ds_read_b64_tr_b16 v[82:83], v12 offset:33792
ds_read_b64_tr_b16 v[84:85], v13 offset:32768
v_mfma_f32_16x16x32_bf16 v[52:55], v[112:115], v[132:135], v[52:55]
ds_read_b64_tr_b16 v[86:87], v13 offset:33792
ds_read_b64_tr_b16 v[88:89], v14 offset:32768
v_mfma_f32_16x16x32_bf16 v[48:51], v[112:115], v[128:131], v[48:51]
ds_read_b64_tr_b16 v[90:91], v14 offset:33792
ds_read_b64_tr_b16 v[92:93], v15 offset:32768
v_mfma_f32_16x16x32_bf16 v[44:47], v[112:115], v[124:127], v[44:47]
ds_read_b64_tr_b16 v[94:95], v15 offset:33792
v_mfma_f32_16x16x32_bf16 v[56:59], v[116:119], v[124:127], v[56:59]
v_mfma_f32_16x16x32_bf16 v[60:63], v[116:119], v[128:131], v[60:63]
v_mfma_f32_16x16x32_bf16 v[64:67], v[116:119], v[132:135], v[64:67]
v_mfma_f32_16x16x32_bf16 v[76:79], v[120:123], v[132:135], v[76:79]
v_mfma_f32_16x16x32_bf16 v[72:75], v[120:123], v[128:131], v[72:75]
v_mfma_f32_16x16x32_bf16 v[68:71], v[120:123], v[124:127], v[68:71]
s_waitcnt lgkmcnt(0)
v_mfma_f32_16x16x32_bf16 v[32:35], v[80:83], v[96:99], v[32:35]
ds_read_b128 v[124:127], v11 offset:0
ds_read_b128 v[128:131], v11 offset:2048
v_mfma_f32_16x16x32_bf16 v[36:39], v[80:83], v[100:103], v[36:39]
ds_read_b128 v[132:135], v11 offset:4096
ds_read_b64_tr_b16 v[108:109], v12 offset:40960
v_mfma_f32_16x16x32_bf16 v[40:43], v[80:83], v[104:107], v[40:43]
ds_read_b64_tr_b16 v[110:111], v12 offset:41984
ds_read_b64_tr_b16 v[112:113], v13 offset:40960
v_mfma_f32_16x16x32_bf16 v[52:55], v[84:87], v[104:107], v[52:55]
ds_read_b64_tr_b16 v[114:115], v13 offset:41984
ds_read_b64_tr_b16 v[116:117], v14 offset:40960
v_mfma_f32_16x16x32_bf16 v[48:51], v[84:87], v[100:103], v[48:51]
ds_read_b64_tr_b16 v[118:119], v14 offset:41984
ds_read_b64_tr_b16 v[120:121], v15 offset:40960
v_mfma_f32_16x16x32_bf16 v[44:47], v[84:87], v[96:99], v[44:47]
ds_read_b64_tr_b16 v[122:123], v15 offset:41984
v_mfma_f32_16x16x32_bf16 v[56:59], v[88:91], v[96:99], v[56:59]
v_mfma_f32_16x16x32_bf16 v[60:63], v[88:91], v[100:103], v[60:63]
v_mfma_f32_16x16x32_bf16 v[64:67], v[88:91], v[104:107], v[64:67]
v_mfma_f32_16x16x32_bf16 v[76:79], v[92:95], v[104:107], v[76:79]
v_mfma_f32_16x16x32_bf16 v[72:75], v[92:95], v[100:103], v[72:75]
v_mfma_f32_16x16x32_bf16 v[68:71], v[92:95], v[96:99], v[68:71]
s_waitcnt lgkmcnt(0)
s_barrier
v_mfma_f32_16x16x32_bf16 v[32:35], v[108:111], v[124:127], v[32:35]
ds_read_b128 v[96:99], v10 offset:12288
ds_read_b128 v[100:103], v10 offset:14336
v_mfma_f32_16x16x32_bf16 v[36:39], v[108:111], v[128:131], v[36:39]
ds_read_b128 v[104:107], v10 offset:16384
ds_read_b64_tr_b16 v[80:81], v12 offset:0
v_mfma_f32_16x16x32_bf16 v[40:43], v[108:111], v[132:135], v[40:43]
ds_read_b64_tr_b16 v[82:83], v12 offset:1024
ds_read_b64_tr_b16 v[84:85], v13 offset:0
v_mfma_f32_16x16x32_bf16 v[52:55], v[112:115], v[132:135], v[52:55]
ds_read_b64_tr_b16 v[86:87], v13 offset:1024
ds_read_b64_tr_b16 v[88:89], v14 offset:0
v_mfma_f32_16x16x32_bf16 v[48:51], v[112:115], v[128:131], v[48:51]
ds_read_b64_tr_b16 v[90:91], v14 offset:1024
ds_read_b64_tr_b16 v[92:93], v15 offset:0
v_mfma_f32_16x16x32_bf16 v[44:47], v[112:115], v[124:127], v[44:47]
ds_read_b64_tr_b16 v[94:95], v15 offset:1024
v_mfma_f32_16x16x32_bf16 v[56:59], v[116:119], v[124:127], v[56:59]
v_mfma_f32_16x16x32_bf16 v[60:63], v[116:119], v[128:131], v[60:63]
v_mfma_f32_16x16x32_bf16 v[64:67], v[116:119], v[132:135], v[64:67]
v_mfma_f32_16x16x32_bf16 v[76:79], v[120:123], v[132:135], v[76:79]
v_mfma_f32_16x16x32_bf16 v[72:75], v[120:123], v[128:131], v[72:75]
v_mfma_f32_16x16x32_bf16 v[68:71], v[120:123], v[124:127], v[68:71]
s_waitcnt lgkmcnt(0)
v_mfma_f32_16x16x32_bf16 v[32:35], v[80:83], v[96:99], v[32:35]
ds_read_b128 v[124:127], v11 offset:12288
ds_read_b128 v[128:131], v11 offset:14336
v_mfma_f32_16x16x32_bf16 v[36:39], v[80:83], v[100:103], v[36:39]
ds_read_b128 v[132:135], v11 offset:16384
ds_read_b64_tr_b16 v[108:109], v12 offset:8192
v_mfma_f32_16x16x32_bf16 v[40:43], v[80:83], v[104:107], v[40:43]
ds_read_b64_tr_b16 v[110:111], v12 offset:9216
ds_read_b64_tr_b16 v[112:113], v13 offset:8192
v_mfma_f32_16x16x32_bf16 v[52:55], v[84:87], v[104:107], v[52:55]
ds_read_b64_tr_b16 v[114:115], v13 offset:9216
ds_read_b64_tr_b16 v[116:117], v14 offset:8192
v_mfma_f32_16x16x32_bf16 v[48:51], v[84:87], v[100:103], v[48:51]
ds_read_b64_tr_b16 v[118:119], v14 offset:9216
ds_read_b64_tr_b16 v[120:121], v15 offset:8192
v_mfma_f32_16x16x32_bf16 v[44:47], v[84:87], v[96:99], v[44:47]
ds_read_b64_tr_b16 v[122:123], v15 offset:9216
v_mfma_f32_16x16x32_bf16 v[56:59], v[88:91], v[96:99], v[56:59]
v_mfma_f32_16x16x32_bf16 v[60:63], v[88:91], v[100:103], v[60:63]
v_mfma_f32_16x16x32_bf16 v[64:67], v[88:91], v[104:107], v[64:67]
v_mfma_f32_16x16x32_bf16 v[76:79], v[92:95], v[104:107], v[76:79]
v_mfma_f32_16x16x32_bf16 v[72:75], v[92:95], v[100:103], v[72:75]
v_mfma_f32_16x16x32_bf16 v[68:71], v[92:95], v[96:99], v[68:71]
s_waitcnt lgkmcnt(0)
s_barrier
v_mfma_f32_16x16x32_bf16 v[32:35], v[108:111], v[124:127], v[32:35]
ds_read_b128 v[96:99], v10 offset:49152
ds_read_b128 v[100:103], v10 offset:51200
v_mfma_f32_16x16x32_bf16 v[36:39], v[108:111], v[128:131], v[36:39]
ds_read_b128 v[104:107], v10 offset:53248
ds_read_b64_tr_b16 v[80:81], v12 offset:16384
v_mfma_f32_16x16x32_bf16 v[40:43], v[108:111], v[132:135], v[40:43]
ds_read_b64_tr_b16 v[82:83], v12 offset:17408
ds_read_b64_tr_b16 v[84:85], v13 offset:16384
v_mfma_f32_16x16x32_bf16 v[52:55], v[112:115], v[132:135], v[52:55]
ds_read_b64_tr_b16 v[86:87], v13 offset:17408
ds_read_b64_tr_b16 v[88:89], v14 offset:16384
v_mfma_f32_16x16x32_bf16 v[48:51], v[112:115], v[128:131], v[48:51]
ds_read_b64_tr_b16 v[90:91], v14 offset:17408
ds_read_b64_tr_b16 v[92:93], v15 offset:16384
v_mfma_f32_16x16x32_bf16 v[44:47], v[112:115], v[124:127], v[44:47]
ds_read_b64_tr_b16 v[94:95], v15 offset:17408
v_mfma_f32_16x16x32_bf16 v[56:59], v[116:119], v[124:127], v[56:59]
v_mfma_f32_16x16x32_bf16 v[60:63], v[116:119], v[128:131], v[60:63]
v_mfma_f32_16x16x32_bf16 v[64:67], v[116:119], v[132:135], v[64:67]
v_mfma_f32_16x16x32_bf16 v[76:79], v[120:123], v[132:135], v[76:79]
v_mfma_f32_16x16x32_bf16 v[72:75], v[120:123], v[128:131], v[72:75]
v_mfma_f32_16x16x32_bf16 v[68:71], v[120:123], v[124:127], v[68:71]
s_waitcnt lgkmcnt(0)
v_mfma_f32_16x16x32_bf16 v[32:35], v[80:83], v[96:99], v[32:35]
ds_read_b128 v[124:127], v11 offset:49152
ds_read_b128 v[128:131], v11 offset:51200
v_mfma_f32_16x16x32_bf16 v[36:39], v[80:83], v[100:103], v[36:39]
ds_read_b128 v[132:135], v11 offset:53248
ds_read_b64_tr_b16 v[108:109], v12 offset:24576
v_mfma_f32_16x16x32_bf16 v[40:43], v[80:83], v[104:107], v[40:43]
ds_read_b64_tr_b16 v[110:111], v12 offset:25600
ds_read_b64_tr_b16 v[112:113], v13 offset:24576
v_mfma_f32_16x16x32_bf16 v[52:55], v[84:87], v[104:107], v[52:55]
ds_read_b64_tr_b16 v[114:115], v13 offset:25600
ds_read_b64_tr_b16 v[116:117], v14 offset:24576
v_mfma_f32_16x16x32_bf16 v[48:51], v[84:87], v[100:103], v[48:51]
ds_read_b64_tr_b16 v[118:119], v14 offset:25600
ds_read_b64_tr_b16 v[120:121], v15 offset:24576
v_mfma_f32_16x16x32_bf16 v[44:47], v[84:87], v[96:99], v[44:47]
ds_read_b64_tr_b16 v[122:123], v15 offset:25600
v_mfma_f32_16x16x32_bf16 v[56:59], v[88:91], v[96:99], v[56:59]
v_mfma_f32_16x16x32_bf16 v[60:63], v[88:91], v[100:103], v[60:63]
v_mfma_f32_16x16x32_bf16 v[64:67], v[88:91], v[104:107], v[64:67]
v_mfma_f32_16x16x32_bf16 v[76:79], v[92:95], v[104:107], v[76:79]
v_mfma_f32_16x16x32_bf16 v[72:75], v[92:95], v[100:103], v[72:75]
v_mfma_f32_16x16x32_bf16 v[68:71], v[92:95], v[96:99], v[68:71]
s_waitcnt lgkmcnt(0)
s_barrier
v_mfma_f32_16x16x32_bf16 v[32:35], v[108:111], v[124:127], v[32:35]
ds_read_b128 v[96:99], v10 offset:24576
ds_read_b128 v[100:103], v10 offset:26624
v_mfma_f32_16x16x32_bf16 v[36:39], v[108:111], v[128:131], v[36:39]
ds_read_b128 v[104:107], v10 offset:28672
ds_read_b64_tr_b16 v[80:81], v12 offset:32768
v_mfma_f32_16x16x32_bf16 v[40:43], v[108:111], v[132:135], v[40:43]
ds_read_b64_tr_b16 v[82:83], v12 offset:33792
ds_read_b64_tr_b16 v[84:85], v13 offset:32768
v_mfma_f32_16x16x32_bf16 v[52:55], v[112:115], v[132:135], v[52:55]
ds_read_b64_tr_b16 v[86:87], v13 offset:33792
ds_read_b64_tr_b16 v[88:89], v14 offset:32768
v_mfma_f32_16x16x32_bf16 v[48:51], v[112:115], v[128:131], v[48:51]
ds_read_b64_tr_b16 v[90:91], v14 offset:33792
ds_read_b64_tr_b16 v[92:93], v15 offset:32768
v_mfma_f32_16x16x32_bf16 v[44:47], v[112:115], v[124:127], v[44:47]
ds_read_b64_tr_b16 v[94:95], v15 offset:33792
v_mfma_f32_16x16x32_bf16 v[56:59], v[116:119], v[124:127], v[56:59]
v_mfma_f32_16x16x32_bf16 v[60:63], v[116:119], v[128:131], v[60:63]
v_mfma_f32_16x16x32_bf16 v[64:67], v[116:119], v[132:135], v[64:67]
v_mfma_f32_16x16x32_bf16 v[76:79], v[120:123], v[132:135], v[76:79]
v_mfma_f32_16x16x32_bf16 v[72:75], v[120:123], v[128:131], v[72:75]
v_mfma_f32_16x16x32_bf16 v[68:71], v[120:123], v[124:127], v[68:71]
s_waitcnt lgkmcnt(0)
v_mfma_f32_16x16x32_bf16 v[32:35], v[80:83], v[96:99], v[32:35]
ds_read_b128 v[124:127], v11 offset:24576
ds_read_b128 v[128:131], v11 offset:26624
v_mfma_f32_16x16x32_bf16 v[36:39], v[80:83], v[100:103], v[36:39]
ds_read_b128 v[132:135], v11 offset:28672
ds_read_b64_tr_b16 v[108:109], v12 offset:40960
v_mfma_f32_16x16x32_bf16 v[40:43], v[80:83], v[104:107], v[40:43]
ds_read_b64_tr_b16 v[110:111], v12 offset:41984
ds_read_b64_tr_b16 v[112:113], v13 offset:40960
v_mfma_f32_16x16x32_bf16 v[52:55], v[84:87], v[104:107], v[52:55]
ds_read_b64_tr_b16 v[114:115], v13 offset:41984
ds_read_b64_tr_b16 v[116:117], v14 offset:40960
v_mfma_f32_16x16x32_bf16 v[48:51], v[84:87], v[100:103], v[48:51]
ds_read_b64_tr_b16 v[118:119], v14 offset:41984
ds_read_b64_tr_b16 v[120:121], v15 offset:40960
v_mfma_f32_16x16x32_bf16 v[44:47], v[84:87], v[96:99], v[44:47]
ds_read_b64_tr_b16 v[122:123], v15 offset:41984
v_mfma_f32_16x16x32_bf16 v[56:59], v[88:91], v[96:99], v[56:59]
v_mfma_f32_16x16x32_bf16 v[60:63], v[88:91], v[100:103], v[60:63]
v_mfma_f32_16x16x32_bf16 v[64:67], v[88:91], v[104:107], v[64:67]
v_mfma_f32_16x16x32_bf16 v[76:79], v[92:95], v[104:107], v[76:79]
v_mfma_f32_16x16x32_bf16 v[72:75], v[92:95], v[100:103], v[72:75]
v_mfma_f32_16x16x32_bf16 v[68:71], v[92:95], v[96:99], v[68:71]
s_waitcnt lgkmcnt(0)
s_barrier
v_mfma_f32_16x16x32_bf16 v[32:35], v[108:111], v[124:127], v[32:35]
ds_read_b128 v[96:99], v10 offset:0
ds_read_b128 v[100:103], v10 offset:2048
v_mfma_f32_16x16x32_bf16 v[36:39], v[108:111], v[128:131], v[36:39]
ds_read_b128 v[104:107], v10 offset:4096
ds_read_b64_tr_b16 v[80:81], v12 offset:0
v_mfma_f32_16x16x32_bf16 v[40:43], v[108:111], v[132:135], v[40:43]
ds_read_b64_tr_b16 v[82:83], v12 offset:1024
ds_read_b64_tr_b16 v[84:85], v13 offset:0
v_mfma_f32_16x16x32_bf16 v[52:55], v[112:115], v[132:135], v[52:55]
ds_read_b64_tr_b16 v[86:87], v13 offset:1024
ds_read_b64_tr_b16 v[88:89], v14 offset:0
v_mfma_f32_16x16x32_bf16 v[48:51], v[112:115], v[128:131], v[48:51]
ds_read_b64_tr_b16 v[90:91], v14 offset:1024
ds_read_b64_tr_b16 v[92:93], v15 offset:0
v_mfma_f32_16x16x32_bf16 v[44:47], v[112:115], v[124:127], v[44:47]
ds_read_b64_tr_b16 v[94:95], v15 offset:1024
v_mfma_f32_16x16x32_bf16 v[56:59], v[116:119], v[124:127], v[56:59]
v_mfma_f32_16x16x32_bf16 v[60:63], v[116:119], v[128:131], v[60:63]
v_mfma_f32_16x16x32_bf16 v[64:67], v[116:119], v[132:135], v[64:67]
v_mfma_f32_16x16x32_bf16 v[76:79], v[120:123], v[132:135], v[76:79]
v_mfma_f32_16x16x32_bf16 v[72:75], v[120:123], v[128:131], v[72:75]
v_mfma_f32_16x16x32_bf16 v[68:71], v[120:123], v[124:127], v[68:71]
s_waitcnt lgkmcnt(0)
v_mfma_f32_16x16x32_bf16 v[32:35], v[80:83], v[96:99], v[32:35]
ds_read_b128 v[124:127], v11 offset:0
ds_read_b128 v[128:131], v11 offset:2048
v_mfma_f32_16x16x32_bf16 v[36:39], v[80:83], v[100:103], v[36:39]
ds_read_b128 v[132:135], v11 offset:4096
ds_read_b64_tr_b16 v[108:109], v12 offset:8192
v_mfma_f32_16x16x32_bf16 v[40:43], v[80:83], v[104:107], v[40:43]
ds_read_b64_tr_b16 v[110:111], v12 offset:9216
ds_read_b64_tr_b16 v[112:113], v13 offset:8192
v_mfma_f32_16x16x32_bf16 v[52:55], v[84:87], v[104:107], v[52:55]
ds_read_b64_tr_b16 v[114:115], v13 offset:9216
ds_read_b64_tr_b16 v[116:117], v14 offset:8192
v_mfma_f32_16x16x32_bf16 v[48:51], v[84:87], v[100:103], v[48:51]
ds_read_b64_tr_b16 v[118:119], v14 offset:9216
ds_read_b64_tr_b16 v[120:121], v15 offset:8192
v_mfma_f32_16x16x32_bf16 v[44:47], v[84:87], v[96:99], v[44:47]
ds_read_b64_tr_b16 v[122:123], v15 offset:9216
v_mfma_f32_16x16x32_bf16 v[56:59], v[88:91], v[96:99], v[56:59]
v_mfma_f32_16x16x32_bf16 v[60:63], v[88:91], v[100:103], v[60:63]
v_mfma_f32_16x16x32_bf16 v[64:67], v[88:91], v[104:107], v[64:67]
v_mfma_f32_16x16x32_bf16 v[76:79], v[92:95], v[104:107], v[76:79]
v_mfma_f32_16x16x32_bf16 v[72:75], v[92:95], v[100:103], v[72:75]
v_mfma_f32_16x16x32_bf16 v[68:71], v[92:95], v[96:99], v[68:71]
s_waitcnt lgkmcnt(0)
s_barrier
v_mfma_f32_16x16x32_bf16 v[32:35], v[108:111], v[124:127], v[32:35]
ds_read_b128 v[96:99], v10 offset:12288
ds_read_b128 v[100:103], v10 offset:14336
v_mfma_f32_16x16x32_bf16 v[36:39], v[108:111], v[128:131], v[36:39]
ds_read_b128 v[104:107], v10 offset:16384
ds_read_b64_tr_b16 v[80:81], v12 offset:16384
v_mfma_f32_16x16x32_bf16 v[40:43], v[108:111], v[132:135], v[40:43]
ds_read_b64_tr_b16 v[82:83], v12 offset:17408
ds_read_b64_tr_b16 v[84:85], v13 offset:16384
v_mfma_f32_16x16x32_bf16 v[52:55], v[112:115], v[132:135], v[52:55]
ds_read_b64_tr_b16 v[86:87], v13 offset:17408
ds_read_b64_tr_b16 v[88:89], v14 offset:16384
v_mfma_f32_16x16x32_bf16 v[48:51], v[112:115], v[128:131], v[48:51]
ds_read_b64_tr_b16 v[90:91], v14 offset:17408
ds_read_b64_tr_b16 v[92:93], v15 offset:16384
v_mfma_f32_16x16x32_bf16 v[44:47], v[112:115], v[124:127], v[44:47]
ds_read_b64_tr_b16 v[94:95], v15 offset:17408
v_mfma_f32_16x16x32_bf16 v[56:59], v[116:119], v[124:127], v[56:59]
v_mfma_f32_16x16x32_bf16 v[60:63], v[116:119], v[128:131], v[60:63]
v_mfma_f32_16x16x32_bf16 v[64:67], v[116:119], v[132:135], v[64:67]
v_mfma_f32_16x16x32_bf16 v[76:79], v[120:123], v[132:135], v[76:79]
v_mfma_f32_16x16x32_bf16 v[72:75], v[120:123], v[128:131], v[72:75]
v_mfma_f32_16x16x32_bf16 v[68:71], v[120:123], v[124:127], v[68:71]
s_waitcnt lgkmcnt(0)
v_mfma_f32_16x16x32_bf16 v[32:35], v[80:83], v[96:99], v[32:35]
ds_read_b128 v[124:127], v11 offset:12288
ds_read_b128 v[128:131], v11 offset:14336
v_mfma_f32_16x16x32_bf16 v[36:39], v[80:83], v[100:103], v[36:39]
ds_read_b128 v[132:135], v11 offset:16384
ds_read_b64_tr_b16 v[108:109], v12 offset:24576
v_mfma_f32_16x16x32_bf16 v[40:43], v[80:83], v[104:107], v[40:43]
ds_read_b64_tr_b16 v[110:111], v12 offset:25600
ds_read_b64_tr_b16 v[112:113], v13 offset:24576
v_mfma_f32_16x16x32_bf16 v[52:55], v[84:87], v[104:107], v[52:55]
ds_read_b64_tr_b16 v[114:115], v13 offset:25600
ds_read_b64_tr_b16 v[116:117], v14 offset:24576
v_mfma_f32_16x16x32_bf16 v[48:51], v[84:87], v[100:103], v[48:51]
ds_read_b64_tr_b16 v[118:119], v14 offset:25600
ds_read_b64_tr_b16 v[120:121], v15 offset:24576
v_mfma_f32_16x16x32_bf16 v[44:47], v[84:87], v[96:99], v[44:47]
ds_read_b64_tr_b16 v[122:123], v15 offset:25600
v_mfma_f32_16x16x32_bf16 v[56:59], v[88:91], v[96:99], v[56:59]
v_mfma_f32_16x16x32_bf16 v[60:63], v[88:91], v[100:103], v[60:63]
v_mfma_f32_16x16x32_bf16 v[64:67], v[88:91], v[104:107], v[64:67]
v_mfma_f32_16x16x32_bf16 v[76:79], v[92:95], v[104:107], v[76:79]
v_mfma_f32_16x16x32_bf16 v[72:75], v[92:95], v[100:103], v[72:75]
v_mfma_f32_16x16x32_bf16 v[68:71], v[92:95], v[96:99], v[68:71]
s_waitcnt lgkmcnt(0)
s_barrier
v_mfma_f32_16x16x32_bf16 v[32:35], v[108:111], v[124:127], v[32:35]
ds_read_b128 v[96:99], v10 offset:49152
ds_read_b128 v[220:223], v11 offset:49152
v_mfma_f32_16x16x32_bf16 v[36:39], v[108:111], v[128:131], v[36:39]
ds_read_b64_tr_b16 v[80:81], v12 offset:32768
ds_read_b64_tr_b16 v[82:83], v12 offset:33792
v_mfma_f32_16x16x32_bf16 v[40:43], v[108:111], v[132:135], v[40:43]
ds_read_b64_tr_b16 v[204:205], v12 offset:40960
ds_read_b64_tr_b16 v[206:207], v12 offset:41984
v_mfma_f32_16x16x32_bf16 v[52:55], v[112:115], v[132:135], v[52:55]
ds_read_b64_tr_b16 v[84:85], v13 offset:32768
ds_read_b64_tr_b16 v[86:87], v13 offset:33792
v_mfma_f32_16x16x32_bf16 v[48:51], v[112:115], v[128:131], v[48:51]
ds_read_b64_tr_b16 v[208:209], v13 offset:40960
ds_read_b64_tr_b16 v[210:211], v13 offset:41984
v_mfma_f32_16x16x32_bf16 v[44:47], v[112:115], v[124:127], v[44:47]
ds_read_b128 v[100:103], v10 offset:51200
ds_read_b128 v[224:227], v11 offset:51200
v_mfma_f32_16x16x32_bf16 v[56:59], v[116:119], v[124:127], v[56:59]
ds_read_b128 v[104:107], v10 offset:53248
ds_read_b128 v[228:231], v11 offset:53248
v_mfma_f32_16x16x32_bf16 v[60:63], v[116:119], v[128:131], v[60:63]
ds_read_b64_tr_b16 v[88:89], v14 offset:32768
ds_read_b64_tr_b16 v[90:91], v14 offset:33792
v_mfma_f32_16x16x32_bf16 v[64:67], v[116:119], v[132:135], v[64:67]
ds_read_b64_tr_b16 v[212:213], v14 offset:40960
ds_read_b64_tr_b16 v[214:215], v14 offset:41984
v_mfma_f32_16x16x32_bf16 v[76:79], v[120:123], v[132:135], v[76:79]
ds_read_b64_tr_b16 v[92:93], v15 offset:32768
ds_read_b64_tr_b16 v[94:95], v15 offset:33792
v_mfma_f32_16x16x32_bf16 v[72:75], v[120:123], v[128:131], v[72:75]
ds_read_b64_tr_b16 v[216:217], v15 offset:40960
ds_read_b64_tr_b16 v[218:219], v15 offset:41984
v_mfma_f32_16x16x32_bf16 v[68:71], v[120:123], v[124:127], v[68:71]
s_waitcnt lgkmcnt(12)
v_mfma_f32_16x16x32_bf16 v[32:35], v[80:83], v[96:99], v[32:35]
v_mfma_f32_16x16x32_bf16 v[32:35], v[204:207], v[220:223], v[32:35]
v_mfma_f32_16x16x32_bf16 v[44:47], v[84:87], v[96:99], v[44:47]
v_mfma_f32_16x16x32_bf16 v[44:47], v[208:211], v[220:223], v[44:47]
s_waitcnt lgkmcnt(8)
v_mfma_f32_16x16x32_bf16 v[36:39], v[80:83], v[100:103], v[36:39]
v_mfma_f32_16x16x32_bf16 v[36:39], v[204:207], v[224:227], v[36:39]
s_nop 2
v_cvt_pk_bf16_f32 v108, v32, v33
v_mfma_f32_16x16x32_bf16 v[48:51], v[84:87], v[100:103], v[48:51]
v_cvt_pk_bf16_f32 v109, v34, v35
ds_write_b64 v21, v[108:109] offset:0
v_mfma_f32_16x16x32_bf16 v[48:51], v[208:211], v[224:227], v[48:51]
v_cvt_pk_bf16_f32 v110, v44, v45
s_waitcnt lgkmcnt(1)
v_mfma_f32_16x16x32_bf16 v[40:43], v[80:83], v[104:107], v[40:43]
v_cvt_pk_bf16_f32 v111, v46, v47
ds_write_b64 v21, v[110:111] offset:512
v_mfma_f32_16x16x32_bf16 v[40:43], v[204:207], v[228:231], v[40:43]
v_cvt_pk_bf16_f32 v112, v36, v37
v_mfma_f32_16x16x32_bf16 v[52:55], v[84:87], v[104:107], v[52:55]
v_cvt_pk_bf16_f32 v113, v38, v39
ds_write_b64 v21, v[112:113] offset:4096
v_mfma_f32_16x16x32_bf16 v[52:55], v[208:211], v[228:231], v[52:55]
v_cvt_pk_bf16_f32 v114, v48, v49
v_mfma_f32_16x16x32_bf16 v[56:59], v[88:91], v[96:99], v[56:59]
v_cvt_pk_bf16_f32 v115, v50, v51
ds_write_b64 v21, v[114:115] offset:4608
v_mfma_f32_16x16x32_bf16 v[56:59], v[212:215], v[220:223], v[56:59]
v_cvt_pk_bf16_f32 v116, v40, v41
v_mfma_f32_16x16x32_bf16 v[68:71], v[92:95], v[96:99], v[68:71]
v_cvt_pk_bf16_f32 v117, v42, v43
ds_write_b64 v21, v[116:117] offset:8192
v_mfma_f32_16x16x32_bf16 v[68:71], v[216:219], v[220:223], v[68:71]
v_cvt_pk_bf16_f32 v118, v52, v53
v_mfma_f32_16x16x32_bf16 v[60:63], v[88:91], v[100:103], v[60:63]
v_cvt_pk_bf16_f32 v119, v54, v55
ds_write_b64 v21, v[118:119] offset:8704
v_mfma_f32_16x16x32_bf16 v[60:63], v[212:215], v[224:227], v[60:63]
v_cvt_pk_bf16_f32 v120, v56, v57
v_mfma_f32_16x16x32_bf16 v[72:75], v[92:95], v[100:103], v[72:75]
v_cvt_pk_bf16_f32 v121, v58, v59
ds_write_b64 v21, v[120:121] offset:1024
v_mfma_f32_16x16x32_bf16 v[72:75], v[216:219], v[224:227], v[72:75]
v_cvt_pk_bf16_f32 v122, v68, v69
v_mfma_f32_16x16x32_bf16 v[64:67], v[88:91], v[104:107], v[64:67]
v_cvt_pk_bf16_f32 v123, v70, v71
ds_write_b64 v21, v[122:123] offset:1536
v_mfma_f32_16x16x32_bf16 v[64:67], v[212:215], v[228:231], v[64:67]
v_cvt_pk_bf16_f32 v124, v60, v61
v_mfma_f32_16x16x32_bf16 v[76:79], v[92:95], v[104:107], v[76:79]
v_cvt_pk_bf16_f32 v125, v62, v63
ds_write_b64 v21, v[124:125] offset:5120
v_mfma_f32_16x16x32_bf16 v[76:79], v[216:219], v[228:231], v[76:79]
v_cvt_pk_bf16_f32 v126, v72, v73
v_cvt_pk_bf16_f32 v127, v74, v75
ds_write_b64 v21, v[126:127] offset:5632
v_cvt_pk_bf16_f32 v128, v64, v65
v_cvt_pk_bf16_f32 v129, v66, v67
ds_write_b64 v21, v[128:129] offset:9216
s_nop 1
v_cvt_pk_bf16_f32 v130, v76, v77
v_cvt_pk_bf16_f32 v131, v78, v79
ds_write_b64 v21, v[130:131] offset:9728
s_and_b32 s3, s21, 1
s_lshl_b32 s3, s3, 6
v_xor_b32 v12, s3, v12
v_xor_b32 v13, s3, v13
v_xor_b32 v14, s3, v14
v_xor_b32 v15, s3, v15
L_unit:
s_waitcnt lgkmcnt(0)
s_barrier
ds_read_b128 v[136:139], v184 offset:0
ds_read_b128 v[152:155], v184 offset:4096
ds_read_b128 v[168:171], v184 offset:8192
ds_read_b128 v[80:83], v254 offset:0
ds_read_b128 v[140:143], v185 offset:0
ds_read_b128 v[156:159], v185 offset:4096
ds_read_b128 v[172:175], v185 offset:8192
ds_read_b128 v[84:87], v254 offset:1024
ds_read_b128 v[144:147], v186 offset:0
ds_read_b128 v[160:163], v186 offset:4096
ds_read_b128 v[176:179], v186 offset:8192
ds_read_b128 v[88:91], v254 offset:2048
ds_read_b128 v[148:151], v187 offset:0
ds_read_b128 v[164:167], v187 offset:4096
ds_read_b128 v[180:183], v187 offset:8192
ds_read_b128 v[92:95], v254 offset:3072
s_waitcnt lgkmcnt(12)
v_mfma_f32_16x16x32_bf16 v[96:99], v[136:139], v[80:83], 0
v_mfma_f32_16x16x32_bf16 v[100:103], v[152:155], v[80:83], 0
v_mfma_f32_16x16x32_bf16 v[104:107], v[168:171], v[80:83], 0
s_waitcnt lgkmcnt(8)
v_mfma_f32_16x16x32_bf16 v[96:99], v[140:143], v[84:87], v[96:99]
v_mfma_f32_16x16x32_bf16 v[100:103], v[156:159], v[84:87], v[100:103]
v_mfma_f32_16x16x32_bf16 v[104:107], v[172:175], v[84:87], v[104:107]
s_waitcnt lgkmcnt(4)
v_mfma_f32_16x16x32_bf16 v[96:99], v[144:147], v[88:91], v[96:99]
v_mfma_f32_16x16x32_bf16 v[100:103], v[160:163], v[88:91], v[100:103]
v_mfma_f32_16x16x32_bf16 v[104:107], v[176:179], v[88:91], v[104:107]
s_waitcnt lgkmcnt(0)
v_mfma_f32_16x16x32_bf16 v[96:99], v[148:151], v[92:95], v[96:99]
v_mfma_f32_16x16x32_bf16 v[100:103], v[164:167], v[92:95], v[100:103]
v_mfma_f32_16x16x32_bf16 v[104:107], v[180:183], v[92:95], v[104:107]
s_nop 5
v_max3_f32 v6, v96, v97, v98
v_max3_f32 v7, v99, v100, v101
v_max3_f32 v6, v6, v102, v103
v_max3_f32 v7, v7, v104, v105
v_max3_f32 v6, v6, v106, v107
v_max_f32 v6, v6, v7
v_mov_b32 v7, v6
s_nop 1
v_permlane16_swap_b32 v6, v7
v_max_f32 v8, v6, v7
v_max_f32 v7, v6, v7
s_nop 1
v_permlane32_swap_b32 v8, v7
v_max_f32 v6, v8, v7
v_mul_f32 v6, s50, v6
v_pk_fma_f32 v[96:97], v[96:97], s[50:51], v[6:7] op_sel_hi:[1,1,0] neg_lo:[0,0,1] neg_hi:[0,0,1]
v_pk_fma_f32 v[98:99], v[98:99], s[50:51], v[6:7] op_sel_hi:[1,1,0] neg_lo:[0,0,1] neg_hi:[0,0,1]
v_pk_fma_f32 v[100:101], v[100:101], s[50:51], v[6:7] op_sel_hi:[1,1,0] neg_lo:[0,0,1] neg_hi:[0,0,1]
v_pk_fma_f32 v[102:103], v[102:103], s[50:51], v[6:7] op_sel_hi:[1,1,0] neg_lo:[0,0,1] neg_hi:[0,0,1]
v_pk_fma_f32 v[104:105], v[104:105], s[50:51], v[6:7] op_sel_hi:[1,1,0] neg_lo:[0,0,1] neg_hi:[0,0,1]
v_pk_fma_f32 v[106:107], v[106:107], s[50:51], v[6:7] op_sel_hi:[1,1,0] neg_lo:[0,0,1] neg_hi:[0,0,1]
v_exp_f32 v96, v96
v_exp_f32 v97, v97
v_exp_f32 v98, v98
v_exp_f32 v99, v99
v_exp_f32 v100, v100
v_exp_f32 v101, v101
v_exp_f32 v102, v102
v_exp_f32 v103, v103
v_exp_f32 v104, v104
v_exp_f32 v105, v105
v_exp_f32 v106, v106
v_exp_f32 v107, v107
v_pk_add_f32 v[6:7], v[96:97], v[98:99]
v_pk_add_f32 v[4:5], v[100:101], v[102:103]
v_pk_add_f32 v[6:7], v[6:7], v[104:105]
v_pk_add_f32 v[4:5], v[4:5], v[106:107]
v_pk_add_f32 v[4:5], v[4:5], v[6:7]
v_add_f32 v6, v4, v5
v_add_f32 v7, v4, v5
s_nop 1
v_permlane16_swap_b32 v6, v7
v_add_f32 v8, v6, v7
v_add_f32 v7, v6, v7
s_nop 1
v_permlane32_swap_b32 v8, v7
v_add_f32 v6, v8, v7
v_rcp_f32 v6, v6
s_nop 0
v_pk_mul_f32 v[96:97], v[96:97], v[6:7] op_sel_hi:[1,0]
v_pk_mul_f32 v[98:99], v[98:99], v[6:7] op_sel_hi:[1,0]
v_pk_mul_f32 v[100:101], v[100:101], v[6:7] op_sel_hi:[1,0]
v_pk_mul_f32 v[102:103], v[102:103], v[6:7] op_sel_hi:[1,0]
v_pk_mul_f32 v[104:105], v[104:105], v[6:7] op_sel_hi:[1,0]
v_pk_mul_f32 v[106:107], v[106:107], v[6:7] op_sel_hi:[1,0]
v_cvt_pk_bf16_f32 v244, v96, v97
v_cvt_pk_bf16_f32 v245, v98, v99
v_cvt_pk_bf16_f32 v246, v100, v101
v_cvt_pk_bf16_f32 v247, v102, v103
v_cvt_pk_bf16_f32 v248, v104, v105
v_cvt_pk_bf16_f32 v249, v106, v107
buffer_store_dwordx4 v[244:247], v25, s[44:47], s49 offen sc1
buffer_store_dwordx2 v[248:249], v26, s[44:47], s49 offen offset:1024 sc1
ds_write_b128 v255, v[244:247]
ds_write_b64 v31, v[248:249] offset:1024
s_barrier
s_cmp_ge_u32 s20, 4
s_cbranch_scc1 L_help2
s_mul_i32 s55, s18, 4608
s_and_b32 s54, s22, 1
s_mul_i32 s54, s54, 4608
s_sub_u32 s54, s54, s55
s_add_u32 s55, s55, 73728
s_lshr_b32 s53, s16, 1
s_xor_b32 s53, s53, s22
s_xor_b32 s53, s53, 3
s_and_b32 s52, s22, 2
s_xor_b32 s52, s52, s53
ds_read_b128 v[96:99], v16 offset:0
ds_read_b64_tr_b16 v[80:81], v12 offset:0
ds_read_b64_tr_b16 v[82:83], v12 offset:1024
ds_read_b128 v[100:103], v16 offset:2048
ds_read_b128 v[104:107], v16 offset:4096
ds_read_b64_tr_b16 v[84:85], v13 offset:0
ds_read_b64_tr_b16 v[86:87], v13 offset:1024
ds_read_b64_tr_b16 v[88:89], v14 offset:0
ds_read_b64_tr_b16 v[90:91], v14 offset:1024
ds_read_b64_tr_b16 v[92:93], v15 offset:0
ds_read_b64_tr_b16 v[94:95], v15 offset:1024
s_waitcnt lgkmcnt(8)
v_mfma_f32_16x16x32_bf16 v[136:139], v[96:99], v[80:83], 0
ds_read_b128 v[124:127], v17 offset:0
s_waitcnt lgkmcnt(8)
v_mfma_f32_16x16x32_bf16 v[140:143], v[100:103], v[80:83], 0
ds_read_b128 v[128:131], v17 offset:2048
s_xor_b32 s3, s53, 0
s_mul_i32 s3, s3, 9216
s_add_u32 s3, s3, s55
s_waitcnt lgkmcnt(8)
v_mfma_f32_16x16x32_bf16 v[144:147], v[104:107], v[80:83], 0
ds_read_b128 v[132:135], v17 offset:4096
s_waitcnt lgkmcnt(7)
v_mfma_f32_16x16x32_bf16 v[156:159], v[104:107], v[84:87], 0
ds_read_b64_tr_b16 v[108:109], v12 offset:8192
v_add_u32 v10, s3, v25
v_mfma_f32_16x16x32_bf16 v[152:155], v[100:103], v[84:87], 0
ds_read_b64_tr_b16 v[110:111], v12 offset:9216
v_mfma_f32_16x16x32_bf16 v[148:151], v[96:99], v[84:87], 0
ds_read_b64_tr_b16 v[112:113], v13 offset:8192
v_add_u32 v4, s3, v26
s_waitcnt lgkmcnt(8)
v_mfma_f32_16x16x32_bf16 v[160:163], v[96:99], v[88:91], 0
ds_read_b64_tr_b16 v[114:115], v13 offset:9216
v_mfma_f32_16x16x32_bf16 v[164:167], v[100:103], v[88:91], 0
ds_read_b64_tr_b16 v[116:117], v14 offset:8192
s_xor_b32 s3, s52, 0
s_mul_i32 s3, s3, 9216
s_add_u32 s3, s3, s55
s_add_u32 s3, s3, s54
v_add_u32 v24, s3, v25
v_mfma_f32_16x16x32_bf16 v[168:171], v[104:107], v[88:91], 0
ds_read_b64_tr_b16 v[118:119], v14 offset:9216
s_waitcnt lgkmcnt(9)
v_mfma_f32_16x16x32_bf16 v[180:183], v[104:107], v[92:95], 0
ds_read_b64_tr_b16 v[120:121], v15 offset:8192
v_add_u32 v8, s3, v26
v_mfma_f32_16x16x32_bf16 v[176:179], v[100:103], v[92:95], 0
ds_read_b64_tr_b16 v[122:123], v15 offset:9216
v_mfma_f32_16x16x32_bf16 v[172:175], v[96:99], v[92:95], 0
s_waitcnt lgkmcnt(4)
v_mfma_f32_16x16x32_bf16 v[136:139], v[124:127], v[108:111], v[136:139]
ds_read_b64_tr_b16 v[80:81], v12 offset:16384
v_mfma_f32_16x16x32_bf16 v[140:143], v[128:131], v[108:111], v[140:143]
ds_read_b64_tr_b16 v[82:83], v12 offset:17408
s_xor_b32 s3, s53, 1
s_mul_i32 s3, s3, 9216
s_add_u32 s3, s3, s55
v_mfma_f32_16x16x32_bf16 v[144:147], v[132:135], v[108:111], v[144:147]
ds_read_b64_tr_b16 v[84:85], v13 offset:16384
v_mfma_f32_16x16x32_bf16 v[156:159], v[132:135], v[112:115], v[156:159]
ds_read_b64_tr_b16 v[86:87], v13 offset:17408
v_add_u32 v11, s3, v25
v_mfma_f32_16x16x32_bf16 v[152:155], v[128:131], v[112:115], v[152:155]
ds_read_b64_tr_b16 v[88:89], v14 offset:16384
v_mfma_f32_16x16x32_bf16 v[148:151], v[124:127], v[112:115], v[148:151]
ds_read_b64_tr_b16 v[90:91], v14 offset:17408
v_add_u32 v5, s3, v26
s_waitcnt lgkmcnt(6)
v_mfma_f32_16x16x32_bf16 v[160:163], v[124:127], v[116:119], v[160:163]
ds_read_b64_tr_b16 v[92:93], v15 offset:16384
v_mfma_f32_16x16x32_bf16 v[164:167], v[128:131], v[116:119], v[164:167]
ds_read_b64_tr_b16 v[94:95], v15 offset:17408
s_xor_b32 s3, s52, 1
s_mul_i32 s3, s3, 9216
s_add_u32 s3, s3, s55
s_add_u32 s3, s3, s54
v_add_u32 v21, s3, v25
v_mfma_f32_16x16x32_bf16 v[168:171], v[132:135], v[116:119], v[168:171]
v_mfma_f32_16x16x32_bf16 v[180:183], v[132:135], v[120:123], v[180:183]
v_add_u32 v9, s3, v26
v_mfma_f32_16x16x32_bf16 v[176:179], v[128:131], v[120:123], v[176:179]
v_mfma_f32_16x16x32_bf16 v[172:175], v[124:127], v[120:123], v[172:175]
s_waitcnt lgkmcnt(4)
v_mfma_f32_16x16x32_bf16 v[32:35], v[96:99], v[80:83], 0
ds_read_b64_tr_b16 v[108:109], v12 offset:24576
v_mfma_f32_16x16x32_bf16 v[36:39], v[100:103], v[80:83], 0
ds_read_b64_tr_b16 v[110:111], v12 offset:25600
s_xor_b32 s3, s53, 2
s_mul_i32 s3, s3, 9216
s_add_u32 s3, s3, s55
v_mfma_f32_16x16x32_bf16 v[40:43], v[104:107], v[80:83], 0
ds_read_b64_tr_b16 v[112:113], v13 offset:24576
v_add_u32 v22, s3, v25
v_mfma_f32_16x16x32_bf16 v[52:55], v[104:107], v[84:87], 0
ds_read_b64_tr_b16 v[114:115], v13 offset:25600
v_mfma_f32_16x16x32_bf16 v[48:51], v[100:103], v[84:87], 0
ds_read_b64_tr_b16 v[116:117], v14 offset:24576
v_add_u32 v6, s3, v26
v_mfma_f32_16x16x32_bf16 v[44:47], v[96:99], v[84:87], 0
ds_read_b64_tr_b16 v[118:119], v14 offset:25600
s_waitcnt lgkmcnt(6)
v_mfma_f32_16x16x32_bf16 v[56:59], v[96:99], v[88:91], 0
ds_read_b64_tr_b16 v[120:121], v15 offset:24576
s_xor_b32 s3, s53, 3
s_mul_i32 s3, s3, 9216
s_add_u32 s3, s3, s55
v_mfma_f32_16x16x32_bf16 v[60:63], v[100:103], v[88:91], 0
ds_read_b64_tr_b16 v[122:123], v15 offset:25600
v_mfma_f32_16x16x32_bf16 v[64:67], v[104:107], v[88:91], 0
v_add_u32 v23, s3, v25
v_mfma_f32_16x16x32_bf16 v[76:79], v[104:107], v[92:95], 0
v_mfma_f32_16x16x32_bf16 v[72:75], v[100:103], v[92:95], 0
v_add_u32 v7, s3, v26
v_mfma_f32_16x16x32_bf16 v[68:71], v[96:99], v[92:95], 0
s_waitcnt lgkmcnt(4)
v_mfma_f32_16x16x32_bf16 v[32:35], v[124:127], v[108:111], v[32:35]
s_waitcnt vmcnt(0)
s_barrier
ds_read_b128 v[96:99], v16 offset:12288
v_mfma_f32_16x16x32_bf16 v[36:39], v[128:131], v[108:111], v[36:39]
ds_read_b128 v[100:103], v16 offset:14336
v_add_u32 v250, 73728, v12
v_mfma_f32_16x16x32_bf16 v[40:43], v[132:135], v[108:111], v[40:43]
ds_read_b128 v[104:107], v16 offset:16384
v_mfma_f32_16x16x32_bf16 v[52:55], v[132:135], v[112:115], v[52:55]
ds_read_b64_tr_b16 v[80:81], v12 offset:32768
v_add_u32 v251, 73728, v13
v_mfma_f32_16x16x32_bf16 v[48:51], v[128:131], v[112:115], v[48:51]
ds_read_b64_tr_b16 v[82:83], v12 offset:33792
v_mfma_f32_16x16x32_bf16 v[44:47], v[124:127], v[112:115], v[44:47]
ds_read_b64_tr_b16 v[84:85], v13 offset:32768
s_waitcnt lgkmcnt(6)
v_mfma_f32_16x16x32_bf16 v[56:59], v[124:127], v[116:119], v[56:59]
ds_read_b64_tr_b16 v[86:87], v13 offset:33792
v_add_u32 v252, 73728, v14
v_mfma_f32_16x16x32_bf16 v[60:63], v[128:131], v[116:119], v[60:63]
ds_read_b64_tr_b16 v[88:89], v14 offset:32768
v_mfma_f32_16x16x32_bf16 v[64:67], v[132:135], v[116:119], v[64:67]
ds_read_b64_tr_b16 v[90:91], v14 offset:33792
v_mfma_f32_16x16x32_bf16 v[76:79], v[132:135], v[120:123], v[76:79]
ds_read_b64_tr_b16 v[92:93], v15 offset:32768
v_add_u32 v253, 73728, v15
v_mfma_f32_16x16x32_bf16 v[72:75], v[128:131], v[120:123], v[72:75]
ds_read_b64_tr_b16 v[94:95], v15 offset:33792
v_mfma_f32_16x16x32_bf16 v[68:71], v[124:127], v[120:123], v[68:71]
s_waitcnt lgkmcnt(4)
v_mfma_f32_16x16x32_bf16 v[136:139], v[96:99], v[80:83], v[136:139]
ds_read_b128 v[124:127], v17 offset:12288
v_mfma_f32_16x16x32_bf16 v[140:143], v[100:103], v[80:83], v[140:143]
ds_read_b128 v[128:131], v17 offset:14336
v_mfma_f32_16x16x32_bf16 v[144:147], v[104:107], v[80:83], v[144:147]
ds_read_b128 v[132:135], v17 offset:16384
v_mfma_f32_16x16x32_bf16 v[156:159], v[104:107], v[84:87], v[156:159]
ds_read_b64_tr_b16 v[108:109], v12 offset:40960
v_mfma_f32_16x16x32_bf16 v[152:155], v[100:103], v[84:87], v[152:155]
ds_read_b64_tr_b16 v[110:111], v12 offset:41984
v_mfma_f32_16x16x32_bf16 v[148:151], v[96:99], v[84:87], v[148:151]
ds_read_b64_tr_b16 v[112:113], v13 offset:40960
s_waitcnt lgkmcnt(6)
v_mfma_f32_16x16x32_bf16 v[160:163], v[96:99], v[88:91], v[160:163]
ds_read_b64_tr_b16 v[114:115], v13 offset:41984
v_mfma_f32_16x16x32_bf16 v[164:167], v[100:103], v[88:91], v[164:167]
ds_read_b64_tr_b16 v[116:117], v14 offset:40960
v_mfma_f32_16x16x32_bf16 v[168:171], v[104:107], v[88:91], v[168:171]
ds_read_b64_tr_b16 v[118:119], v14 offset:41984
v_mfma_f32_16x16x32_bf16 v[180:183], v[104:107], v[92:95], v[180:183]
ds_read_b64_tr_b16 v[120:121], v15 offset:40960
v_mfma_f32_16x16x32_bf16 v[176:179], v[100:103], v[92:95], v[176:179]
ds_read_b64_tr_b16 v[122:123], v15 offset:41984
v_mfma_f32_16x16x32_bf16 v[172:175], v[96:99], v[92:95], v[172:175]
s_waitcnt lgkmcnt(4)
v_mfma_f32_16x16x32_bf16 v[136:139], v[124:127], v[108:111], v[136:139]
s_barrier
ds_read_b64_tr_b16 v[80:81], v250 offset:0
v_mfma_f32_16x16x32_bf16 v[140:143], v[128:131], v[108:111], v[140:143]
ds_read_b64_tr_b16 v[82:83], v250 offset:1024
v_mfma_f32_16x16x32_bf16 v[144:147], v[132:135], v[108:111], v[144:147]
ds_read_b64_tr_b16 v[84:85], v251 offset:0
v_mfma_f32_16x16x32_bf16 v[156:159], v[132:135], v[112:115], v[156:159]
ds_read_b64_tr_b16 v[86:87], v251 offset:1024
v_mfma_f32_16x16x32_bf16 v[152:155], v[128:131], v[112:115], v[152:155]
ds_read_b64_tr_b16 v[88:89], v252 offset:0
v_mfma_f32_16x16x32_bf16 v[148:151], v[124:127], v[112:115], v[148:151]
ds_read_b64_tr_b16 v[90:91], v252 offset:1024
s_waitcnt lgkmcnt(6)
v_mfma_f32_16x16x32_bf16 v[160:163], v[124:127], v[116:119], v[160:163]
ds_read_b64_tr_b16 v[92:93], v253 offset:0
v_mfma_f32_16x16x32_bf16 v[164:167], v[128:131], v[116:119], v[164:167]
ds_read_b64_tr_b16 v[94:95], v253 offset:1024
v_mfma_f32_16x16x32_bf16 v[168:171], v[132:135], v[116:119], v[168:171]
v_mfma_f32_16x16x32_bf16 v[180:183], v[132:135], v[120:123], v[180:183]
v_mfma_f32_16x16x32_bf16 v[176:179], v[128:131], v[120:123], v[176:179]
v_mfma_f32_16x16x32_bf16 v[172:175], v[124:127], v[120:123], v[172:175]
s_waitcnt lgkmcnt(4)
v_mfma_f32_16x16x32_bf16 v[32:35], v[96:99], v[80:83], v[32:35]
ds_read_b64_tr_b16 v[108:109], v250 offset:8192
v_mfma_f32_16x16x32_bf16 v[36:39], v[100:103], v[80:83], v[36:39]
ds_read_b64_tr_b16 v[110:111], v250 offset:9216
v_cvt_pk_bf16_f32 v184, v136, v137
v_cvt_pk_bf16_f32 v185, v138, v139
v_mfma_f32_16x16x32_bf16 v[40:43], v[104:107], v[80:83], v[40:43]
ds_read_b64_tr_b16 v[112:113], v251 offset:8192
v_cvt_pk_bf16_f32 v186, v140, v141
v_mfma_f32_16x16x32_bf16 v[52:55], v[104:107], v[84:87], v[52:55]
ds_read_b64_tr_b16 v[114:115], v251 offset:9216
v_cvt_pk_bf16_f32 v187, v142, v143
v_mfma_f32_16x16x32_bf16 v[48:51], v[100:103], v[84:87], v[48:51]
ds_read_b64_tr_b16 v[116:117], v252 offset:8192
v_cvt_pk_bf16_f32 v188, v144, v145
v_mfma_f32_16x16x32_bf16 v[44:47], v[96:99], v[84:87], v[44:47]
ds_read_b64_tr_b16 v[118:119], v252 offset:9216
v_cvt_pk_bf16_f32 v189, v146, v147
s_waitcnt lgkmcnt(6)
v_mfma_f32_16x16x32_bf16 v[56:59], v[96:99], v[88:91], v[56:59]
ds_read_b64_tr_b16 v[120:121], v253 offset:8192
v_cvt_pk_bf16_f32 v196, v148, v149
v_mfma_f32_16x16x32_bf16 v[60:63], v[100:103], v[88:91], v[60:63]
ds_read_b64_tr_b16 v[122:123], v253 offset:9216
v_cvt_pk_bf16_f32 v197, v150, v151
v_mfma_f32_16x16x32_bf16 v[64:67], v[104:107], v[88:91], v[64:67]
v_cvt_pk_bf16_f32 v198, v152, v153
v_mfma_f32_16x16x32_bf16 v[76:79], v[104:107], v[92:95], v[76:79]
v_cvt_pk_bf16_f32 v199, v154, v155
v_mfma_f32_16x16x32_bf16 v[72:75], v[100:103], v[92:95], v[72:75]
v_cvt_pk_bf16_f32 v200, v156, v157
v_mfma_f32_16x16x32_bf16 v[68:71], v[96:99], v[92:95], v[68:71]
v_cvt_pk_bf16_f32 v201, v158, v159
s_waitcnt lgkmcnt(4)
v_mfma_f32_16x16x32_bf16 v[32:35], v[124:127], v[108:111], v[32:35]
s_barrier
ds_read_b128 v[96:99], v16 offset:24576
v_mfma_f32_16x16x32_bf16 v[36:39], v[128:131], v[108:111], v[36:39]
ds_read_b128 v[100:103], v16 offset:26624
v_cvt_pk_bf16_f32 v208, v160, v161
v_cvt_pk_bf16_f32 v209, v162, v163
v_mfma_f32_16x16x32_bf16 v[40:43], v[132:135], v[108:111], v[40:43]
ds_read_b128 v[104:107], v16 offset:28672
v_cvt_pk_bf16_f32 v210, v164, v165
v_mfma_f32_16x16x32_bf16 v[52:55], v[132:135], v[112:115], v[52:55]
ds_read_b64_tr_b16 v[80:81], v12 offset:49152
v_cvt_pk_bf16_f32 v211, v166, v167
v_mfma_f32_16x16x32_bf16 v[48:51], v[128:131], v[112:115], v[48:51]
ds_read_b64_tr_b16 v[82:83], v12 offset:50176
v_cvt_pk_bf16_f32 v212, v168, v169
v_mfma_f32_16x16x32_bf16 v[44:47], v[124:127], v[112:115], v[44:47]
ds_read_b64_tr_b16 v[84:85], v13 offset:49152
v_cvt_pk_bf16_f32 v213, v170, v171
s_waitcnt lgkmcnt(6)
v_mfma_f32_16x16x32_bf16 v[56:59], v[124:127], v[116:119], v[56:59]
ds_read_b64_tr_b16 v[86:87], v13 offset:50176
v_cvt_pk_bf16_f32 v220, v172, v173
v_mfma_f32_16x16x32_bf16 v[60:63], v[128:131], v[116:119], v[60:63]
ds_read_b64_tr_b16 v[88:89], v14 offset:49152
v_cvt_pk_bf16_f32 v221, v174, v175
v_mfma_f32_16x16x32_bf16 v[64:67], v[132:135], v[116:119], v[64:67]
ds_read_b64_tr_b16 v[90:91], v14 offset:50176
v_cvt_pk_bf16_f32 v222, v176, v177
v_mfma_f32_16x16x32_bf16 v[76:79], v[132:135], v[120:123], v[76:79]
ds_read_b64_tr_b16 v[92:93], v15 offset:49152
v_cvt_pk_bf16_f32 v223, v178, v179
v_mfma_f32_16x16x32_bf16 v[72:75], v[128:131], v[120:123], v[72:75]
ds_read_b64_tr_b16 v[94:95], v15 offset:50176
v_cvt_pk_bf16_f32 v224, v180, v181
v_mfma_f32_16x16x32_bf16 v[68:71], v[124:127], v[120:123], v[68:71]
v_cvt_pk_bf16_f32 v225, v182, v183
s_waitcnt lgkmcnt(4)
v_mfma_f32_16x16x32_bf16 v[136:139], v[96:99], v[80:83], 0
ds_read_b128 v[124:127], v17 offset:24576
v_mfma_f32_16x16x32_bf16 v[140:143], v[100:103], v[80:83], 0
ds_read_b128 v[128:131], v17 offset:26624
v_cvt_pk_bf16_f32 v192, v32, v33
v_mfma_f32_16x16x32_bf16 v[144:147], v[104:107], v[80:83], 0
ds_read_b128 v[132:135], v17 offset:28672
v_cvt_pk_bf16_f32 v193, v34, v35
v_mfma_f32_16x16x32_bf16 v[156:159], v[104:107], v[84:87], 0
ds_read_b64_tr_b16 v[108:109], v12 offset:57344
v_cvt_pk_bf16_f32 v194, v36, v37
v_mfma_f32_16x16x32_bf16 v[152:155], v[100:103], v[84:87], 0
ds_read_b64_tr_b16 v[110:111], v12 offset:58368
v_cvt_pk_bf16_f32 v195, v38, v39
v_mfma_f32_16x16x32_bf16 v[148:151], v[96:99], v[84:87], 0
ds_read_b64_tr_b16 v[112:113], v13 offset:57344
v_cvt_pk_bf16_f32 v190, v40, v41
s_waitcnt lgkmcnt(6)
v_mfma_f32_16x16x32_bf16 v[160:163], v[96:99], v[88:91], 0
ds_read_b64_tr_b16 v[114:115], v13 offset:58368
v_cvt_pk_bf16_f32 v191, v42, v43
v_mfma_f32_16x16x32_bf16 v[164:167], v[100:103], v[88:91], 0
ds_read_b64_tr_b16 v[116:117], v14 offset:57344
v_cvt_pk_bf16_f32 v204, v44, v45
v_mfma_f32_16x16x32_bf16 v[168:171], v[104:107], v[88:91], 0
ds_read_b64_tr_b16 v[118:119], v14 offset:58368
v_cvt_pk_bf16_f32 v205, v46, v47
v_mfma_f32_16x16x32_bf16 v[180:183], v[104:107], v[92:95], 0
ds_read_b64_tr_b16 v[120:121], v15 offset:57344
v_cvt_pk_bf16_f32 v206, v48, v49
v_mfma_f32_16x16x32_bf16 v[176:179], v[100:103], v[92:95], 0
ds_read_b64_tr_b16 v[122:123], v15 offset:58368
v_cvt_pk_bf16_f32 v207, v50, v51
v_mfma_f32_16x16x32_bf16 v[172:175], v[96:99], v[92:95], 0
s_waitcnt lgkmcnt(4)
v_mfma_f32_16x16x32_bf16 v[136:139], v[124:127], v[108:111], v[136:139]
s_barrier
ds_read_b64_tr_b16 v[80:81], v12 offset:0
v_mfma_f32_16x16x32_bf16 v[140:143], v[128:131], v[108:111], v[140:143]
ds_read_b64_tr_b16 v[82:83], v12 offset:1024
v_cvt_pk_bf16_f32 v202, v52, v53
v_cvt_pk_bf16_f32 v203, v54, v55
v_mfma_f32_16x16x32_bf16 v[144:147], v[132:135], v[108:111], v[144:147]
ds_read_b64_tr_b16 v[84:85], v13 offset:0
v_cvt_pk_bf16_f32 v216, v56, v57
v_mfma_f32_16x16x32_bf16 v[156:159], v[132:135], v[112:115], v[156:159]
ds_read_b64_tr_b16 v[86:87], v13 offset:1024
v_cvt_pk_bf16_f32 v217, v58, v59
v_mfma_f32_16x16x32_bf16 v[152:155], v[128:131], v[112:115], v[152:155]
ds_read_b64_tr_b16 v[88:89], v14 offset:0
v_cvt_pk_bf16_f32 v218, v60, v61
v_cvt_pk_bf16_f32 v219, v62, v63
v_mfma_f32_16x16x32_bf16 v[148:151], v[124:127], v[112:115], v[148:151]
ds_read_b64_tr_b16 v[90:91], v14 offset:1024
v_cvt_pk_bf16_f32 v214, v64, v65
s_waitcnt lgkmcnt(6)
v_mfma_f32_16x16x32_bf16 v[160:163], v[124:127], v[116:119], v[160:163]
ds_read_b64_tr_b16 v[92:93], v15 offset:0
v_cvt_pk_bf16_f32 v215, v66, v67
v_mfma_f32_16x16x32_bf16 v[164:167], v[128:131], v[116:119], v[164:167]
ds_read_b64_tr_b16 v[94:95], v15 offset:1024
v_cvt_pk_bf16_f32 v228, v68, v69
v_mfma_f32_16x16x32_bf16 v[168:171], v[132:135], v[116:119], v[168:171]
v_cvt_pk_bf16_f32 v229, v70, v71
v_cvt_pk_bf16_f32 v230, v72, v73
v_mfma_f32_16x16x32_bf16 v[180:183], v[132:135], v[120:123], v[180:183]
v_cvt_pk_bf16_f32 v231, v74, v75
v_mfma_f32_16x16x32_bf16 v[176:179], v[128:131], v[120:123], v[176:179]
v_cvt_pk_bf16_f32 v226, v76, v77
v_mfma_f32_16x16x32_bf16 v[172:175], v[124:127], v[120:123], v[172:175]
v_cvt_pk_bf16_f32 v227, v78, v79
s_waitcnt lgkmcnt(4)
v_mfma_f32_16x16x32_bf16 v[32:35], v[96:99], v[80:83], 0
ds_read_b64_tr_b16 v[108:109], v12 offset:8192
v_mfma_f32_16x16x32_bf16 v[36:39], v[100:103], v[80:83], 0
ds_read_b64_tr_b16 v[110:111], v12 offset:9216
v_mfma_f32_16x16x32_bf16 v[40:43], v[104:107], v[80:83], 0
ds_read_b64_tr_b16 v[112:113], v13 offset:8192
v_mfma_f32_16x16x32_bf16 v[52:55], v[104:107], v[84:87], 0
ds_read_b64_tr_b16 v[114:115], v13 offset:9216
v_mfma_f32_16x16x32_bf16 v[48:51], v[100:103], v[84:87], 0
ds_read_b64_tr_b16 v[116:117], v14 offset:8192
v_mfma_f32_16x16x32_bf16 v[44:47], v[96:99], v[84:87], 0
ds_read_b64_tr_b16 v[118:119], v14 offset:9216
s_waitcnt lgkmcnt(6)
v_mfma_f32_16x16x32_bf16 v[56:59], v[96:99], v[88:91], 0
ds_read_b64_tr_b16 v[120:121], v15 offset:8192
v_mfma_f32_16x16x32_bf16 v[60:63], v[100:103], v[88:91], 0
ds_read_b64_tr_b16 v[122:123], v15 offset:9216
v_mfma_f32_16x16x32_bf16 v[64:67], v[104:107], v[88:91], 0
v_mfma_f32_16x16x32_bf16 v[76:79], v[104:107], v[92:95], 0
v_mfma_f32_16x16x32_bf16 v[72:75], v[100:103], v[92:95], 0
v_mfma_f32_16x16x32_bf16 v[68:71], v[96:99], v[92:95], 0
s_waitcnt lgkmcnt(4)
v_mfma_f32_16x16x32_bf16 v[32:35], v[124:127], v[108:111], v[32:35]
s_barrier
ds_read_b128 v[96:99], v16 offset:36864
v_mfma_f32_16x16x32_bf16 v[36:39], v[128:131], v[108:111], v[36:39]
ds_read_b128 v[100:103], v16 offset:38912
v_mfma_f32_16x16x32_bf16 v[40:43], v[132:135], v[108:111], v[40:43]
ds_read_b128 v[104:107], v16 offset:40960
v_mfma_f32_16x16x32_bf16 v[52:55], v[132:135], v[112:115], v[52:55]
ds_read_b64_tr_b16 v[80:81], v12 offset:16384
v_mfma_f32_16x16x32_bf16 v[48:51], v[128:131], v[112:115], v[48:51]
ds_read_b64_tr_b16 v[82:83], v12 offset:17408
v_mfma_f32_16x16x32_bf16 v[44:47], v[124:127], v[112:115], v[44:47]
ds_read_b64_tr_b16 v[84:85], v13 offset:16384
s_waitcnt lgkmcnt(6)
v_mfma_f32_16x16x32_bf16 v[56:59], v[124:127], v[116:119], v[56:59]
ds_read_b64_tr_b16 v[86:87], v13 offset:17408
v_mfma_f32_16x16x32_bf16 v[60:63], v[128:131], v[116:119], v[60:63]
ds_read_b64_tr_b16 v[88:89], v14 offset:16384
v_mfma_f32_16x16x32_bf16 v[64:67], v[132:135], v[116:119], v[64:67]
ds_read_b64_tr_b16 v[90:91], v14 offset:17408
v_mfma_f32_16x16x32_bf16 v[76:79], v[132:135], v[120:123], v[76:79]
ds_read_b64_tr_b16 v[92:93], v15 offset:16384
v_mfma_f32_16x16x32_bf16 v[72:75], v[128:131], v[120:123], v[72:75]
ds_read_b64_tr_b16 v[94:95], v15 offset:17408
v_mfma_f32_16x16x32_bf16 v[68:71], v[124:127], v[120:123], v[68:71]
s_waitcnt lgkmcnt(4)
v_mfma_f32_16x16x32_bf16 v[136:139], v[96:99], v[80:83], v[136:139]
ds_read_b128 v[124:127], v17 offset:36864
v_mfma_f32_16x16x32_bf16 v[140:143], v[100:103], v[80:83], v[140:143]
ds_read_b128 v[128:131], v17 offset:38912
v_mfma_f32_16x16x32_bf16 v[144:147], v[104:107], v[80:83], v[144:147]
ds_read_b128 v[132:135], v17 offset:40960
v_mfma_f32_16x16x32_bf16 v[156:159], v[104:107], v[84:87], v[156:159]
ds_read_b64_tr_b16 v[108:109], v12 offset:24576
v_mfma_f32_16x16x32_bf16 v[152:155], v[100:103], v[84:87], v[152:155]
ds_read_b64_tr_b16 v[110:111], v12 offset:25600
v_mfma_f32_16x16x32_bf16 v[148:151], v[96:99], v[84:87], v[148:151]
ds_read_b64_tr_b16 v[112:113], v13 offset:24576
s_waitcnt lgkmcnt(6)
v_mfma_f32_16x16x32_bf16 v[160:163], v[96:99], v[88:91], v[160:163]
ds_read_b64_tr_b16 v[114:115], v13 offset:25600
v_mfma_f32_16x16x32_bf16 v[164:167], v[100:103], v[88:91], v[164:167]
ds_read_b64_tr_b16 v[116:117], v14 offset:24576
v_mfma_f32_16x16x32_bf16 v[168:171], v[104:107], v[88:91], v[168:171]
ds_read_b64_tr_b16 v[118:119], v14 offset:25600
v_mfma_f32_16x16x32_bf16 v[180:183], v[104:107], v[92:95], v[180:183]
ds_read_b64_tr_b16 v[120:121], v15 offset:24576
v_mfma_f32_16x16x32_bf16 v[176:179], v[100:103], v[92:95], v[176:179]
ds_read_b64_tr_b16 v[122:123], v15 offset:25600
v_mfma_f32_16x16x32_bf16 v[172:175], v[96:99], v[92:95], v[172:175]
s_waitcnt lgkmcnt(4)
v_mfma_f32_16x16x32_bf16 v[136:139], v[124:127], v[108:111], v[136:139]
s_barrier
ds_read_b64_tr_b16 v[80:81], v12 offset:32768
v_mfma_f32_16x16x32_bf16 v[140:143], v[128:131], v[108:111], v[140:143]
ds_read_b64_tr_b16 v[82:83], v12 offset:33792
v_mfma_f32_16x16x32_bf16 v[144:147], v[132:135], v[108:111], v[144:147]
ds_read_b64_tr_b16 v[84:85], v13 offset:32768
v_mfma_f32_16x16x32_bf16 v[156:159], v[132:135], v[112:115], v[156:159]
ds_read_b64_tr_b16 v[86:87], v13 offset:33792
v_mfma_f32_16x16x32_bf16 v[152:155], v[128:131], v[112:115], v[152:155]
ds_read_b64_tr_b16 v[88:89], v14 offset:32768
v_mfma_f32_16x16x32_bf16 v[148:151], v[124:127], v[112:115], v[148:151]
ds_read_b64_tr_b16 v[90:91], v14 offset:33792
s_waitcnt lgkmcnt(6)
v_mfma_f32_16x16x32_bf16 v[160:163], v[124:127], v[116:119], v[160:163]
ds_read_b64_tr_b16 v[92:93], v15 offset:32768
v_mfma_f32_16x16x32_bf16 v[164:167], v[128:131], v[116:119], v[164:167]
ds_read_b64_tr_b16 v[94:95], v15 offset:33792
v_mfma_f32_16x16x32_bf16 v[168:171], v[132:135], v[116:119], v[168:171]
v_mfma_f32_16x16x32_bf16 v[180:183], v[132:135], v[120:123], v[180:183]
v_mfma_f32_16x16x32_bf16 v[176:179], v[128:131], v[120:123], v[176:179]
v_mfma_f32_16x16x32_bf16 v[172:175], v[124:127], v[120:123], v[172:175]
s_waitcnt lgkmcnt(4)
v_mfma_f32_16x16x32_bf16 v[32:35], v[96:99], v[80:83], v[32:35]
ds_read_b64_tr_b16 v[108:109], v12 offset:40960
v_mfma_f32_16x16x32_bf16 v[36:39], v[100:103], v[80:83], v[36:39]
ds_read_b64_tr_b16 v[110:111], v12 offset:41984
v_cvt_pk_bf16_f32 v136, v136, v137
v_cvt_pk_bf16_f32 v137, v138, v139
v_mfma_f32_16x16x32_bf16 v[40:43], v[104:107], v[80:83], v[40:43]
ds_read_b64_tr_b16 v[112:113], v13 offset:40960
v_cvt_pk_bf16_f32 v138, v140, v141
v_mfma_f32_16x16x32_bf16 v[52:55], v[104:107], v[84:87], v[52:55]
ds_read_b64_tr_b16 v[114:115], v13 offset:41984
v_cvt_pk_bf16_f32 v139, v142, v143
v_mfma_f32_16x16x32_bf16 v[48:51], v[100:103], v[84:87], v[48:51]
ds_read_b64_tr_b16 v[116:117], v14 offset:40960
v_cvt_pk_bf16_f32 v140, v144, v145
v_mfma_f32_16x16x32_bf16 v[44:47], v[96:99], v[84:87], v[44:47]
ds_read_b64_tr_b16 v[118:119], v14 offset:41984
v_cvt_pk_bf16_f32 v141, v146, v147
s_waitcnt lgkmcnt(6)
v_mfma_f32_16x16x32_bf16 v[56:59], v[96:99], v[88:91], v[56:59]
ds_read_b64_tr_b16 v[120:121], v15 offset:40960
v_cvt_pk_bf16_f32 v148, v148, v149
v_mfma_f32_16x16x32_bf16 v[60:63], v[100:103], v[88:91], v[60:63]
ds_read_b64_tr_b16 v[122:123], v15 offset:41984
v_cvt_pk_bf16_f32 v149, v150, v151
v_mfma_f32_16x16x32_bf16 v[64:67], v[104:107], v[88:91], v[64:67]
v_cvt_pk_bf16_f32 v150, v152, v153
v_mfma_f32_16x16x32_bf16 v[76:79], v[104:107], v[92:95], v[76:79]
v_cvt_pk_bf16_f32 v151, v154, v155
v_mfma_f32_16x16x32_bf16 v[72:75], v[100:103], v[92:95], v[72:75]
v_cvt_pk_bf16_f32 v152, v156, v157
v_mfma_f32_16x16x32_bf16 v[68:71], v[96:99], v[92:95], v[68:71]
v_cvt_pk_bf16_f32 v153, v158, v159
s_waitcnt lgkmcnt(4)
v_mfma_f32_16x16x32_bf16 v[32:35], v[124:127], v[108:111], v[32:35]
s_barrier
ds_read_b128 v[80:83], v10 offset:0
v_mfma_f32_16x16x32_bf16 v[36:39], v[128:131], v[108:111], v[36:39]
ds_read_b64 v[84:85], v4 offset:1024
v_cvt_pk_bf16_f32 v160, v160, v161
v_cvt_pk_bf16_f32 v161, v162, v163
v_mfma_f32_16x16x32_bf16 v[40:43], v[132:135], v[108:111], v[40:43]
ds_read_b64 v[86:87], v5 offset:1024
v_cvt_pk_bf16_f32 v162, v164, v165
v_mfma_f32_16x16x32_bf16 v[52:55], v[132:135], v[112:115], v[52:55]
ds_read_b128 v[88:91], v11 offset:0
v_cvt_pk_bf16_f32 v163, v166, v167
v_mfma_f32_16x16x32_bf16 v[48:51], v[128:131], v[112:115], v[48:51]
ds_read_b128 v[92:95], v22 offset:0
v_cvt_pk_bf16_f32 v164, v168, v169
v_mfma_f32_16x16x32_bf16 v[44:47], v[124:127], v[112:115], v[44:47]
ds_read_b64 v[96:97], v6 offset:1024
v_cvt_pk_bf16_f32 v165, v170, v171
s_waitcnt lgkmcnt(6)
v_mfma_f32_16x16x32_bf16 v[56:59], v[124:127], v[116:119], v[56:59]
ds_read_b64 v[98:99], v7 offset:1024
v_cvt_pk_bf16_f32 v172, v172, v173
v_mfma_f32_16x16x32_bf16 v[60:63], v[128:131], v[116:119], v[60:63]
ds_read_b128 v[100:103], v23 offset:0
v_cvt_pk_bf16_f32 v173, v174, v175
v_mfma_f32_16x16x32_bf16 v[64:67], v[132:135], v[116:119], v[64:67]
v_cvt_pk_bf16_f32 v174, v176, v177
v_mfma_f32_16x16x32_bf16 v[76:79], v[132:135], v[120:123], v[76:79]
v_cvt_pk_bf16_f32 v175, v178, v179
v_mfma_f32_16x16x32_bf16 v[72:75], v[128:131], v[120:123], v[72:75]
v_cvt_pk_bf16_f32 v176, v180, v181
v_mfma_f32_16x16x32_bf16 v[68:71], v[124:127], v[120:123], v[68:71]
v_cvt_pk_bf16_f32 v177, v182, v183
s_waitcnt lgkmcnt(4)
v_mfma_f32_16x16x32_bf16 v[244:247], v[184:187], v[80:83], 0
ds_read_b128 v[108:111], v10 offset:1536
v_mfma_f32_16x16x32_bf16 v[248:251], v[196:199], v[80:83], 0
ds_read_b64 v[112:113], v4 offset:2560
v_mfma_f32_16x16x32_bf16 v[252:255], v[208:211], v[80:83], 0
ds_read_b64 v[114:115], v5 offset:2560
v_mfma_f32_16x16x32_bf16 v[104:107], v[220:223], v[80:83], 0
ds_read_b128 v[116:119], v11 offset:1536
v_cvt_pk_bf16_f32 v142, v40, v41
v_cvt_pk_bf16_f32 v143, v42, v43
v_mfma_f32_16x16x32_bf16 v[244:247], v[188:191], v[84:87], v[244:247]
ds_read_b128 v[120:123], v22 offset:1536
v_cvt_pk_bf16_f32 v154, v52, v53
v_mfma_f32_16x16x32_bf16 v[248:251], v[200:203], v[84:87], v[248:251]
ds_read_b64 v[124:125], v6 offset:2560
v_cvt_pk_bf16_f32 v155, v54, v55
v_cvt_pk_bf16_f32 v166, v64, v65
v_mfma_f32_16x16x32_bf16 v[252:255], v[212:215], v[84:87], v[252:255]
ds_read_b64 v[126:127], v7 offset:2560
v_cvt_pk_bf16_f32 v167, v66, v67
v_mfma_f32_16x16x32_bf16 v[104:107], v[224:227], v[84:87], v[104:107]
ds_read_b128 v[128:131], v23 offset:1536
v_cvt_pk_bf16_f32 v178, v76, v77
v_cvt_pk_bf16_f32 v179, v78, v79
v_mfma_f32_16x16x32_bf16 v[244:247], v[192:195], v[88:91], v[244:247]
v_cvt_pk_bf16_f32 v144, v32, v33
v_mfma_f32_16x16x32_bf16 v[248:251], v[204:207], v[88:91], v[248:251]
v_cvt_pk_bf16_f32 v145, v34, v35
v_cvt_pk_bf16_f32 v146, v36, v37
v_mfma_f32_16x16x32_bf16 v[252:255], v[216:219], v[88:91], v[252:255]
v_cvt_pk_bf16_f32 v147, v38, v39
s_waitcnt lgkmcnt(8)
v_mfma_f32_16x16x32_bf16 v[104:107], v[228:231], v[88:91], v[104:107]
v_cvt_pk_bf16_f32 v156, v44, v45
v_cvt_pk_bf16_f32 v157, v46, v47
v_mfma_f32_16x16x32_bf16 v[244:247], v[136:139], v[92:95], v[244:247]
v_cvt_pk_bf16_f32 v158, v48, v49
v_mfma_f32_16x16x32_bf16 v[248:251], v[148:151], v[92:95], v[248:251]
v_cvt_pk_bf16_f32 v159, v50, v51
v_cvt_pk_bf16_f32 v168, v56, v57
v_mfma_f32_16x16x32_bf16 v[252:255], v[160:163], v[92:95], v[252:255]
v_cvt_pk_bf16_f32 v169, v58, v59
v_mfma_f32_16x16x32_bf16 v[104:107], v[172:175], v[92:95], v[104:107]
v_cvt_pk_bf16_f32 v170, v60, v61
v_cvt_pk_bf16_f32 v171, v62, v63
v_mfma_f32_16x16x32_bf16 v[244:247], v[140:143], v[96:99], v[244:247]
v_cvt_pk_bf16_f32 v180, v68, v69
v_mfma_f32_16x16x32_bf16 v[248:251], v[152:155], v[96:99], v[248:251]
v_cvt_pk_bf16_f32 v181, v70, v71
v_cvt_pk_bf16_f32 v182, v72, v73
v_mfma_f32_16x16x32_bf16 v[252:255], v[164:167], v[96:99], v[252:255]
v_cvt_pk_bf16_f32 v183, v74, v75
v_mfma_f32_16x16x32_bf16 v[104:107], v[176:179], v[96:99], v[104:107]
v_mfma_f32_16x16x32_bf16 v[244:247], v[144:147], v[100:103], v[244:247]
v_mfma_f32_16x16x32_bf16 v[248:251], v[156:159], v[100:103], v[248:251]
v_mfma_f32_16x16x32_bf16 v[252:255], v[168:171], v[100:103], v[252:255]
v_mfma_f32_16x16x32_bf16 v[104:107], v[180:183], v[100:103], v[104:107]
s_waitcnt lgkmcnt(4)
v_mfma_f32_16x16x32_bf16 v[32:35], v[184:187], v[108:111], 0
ds_read_b128 v[80:83], v10 offset:3072
v_mfma_f32_16x16x32_bf16 v[32:35], v[188:191], v[112:115], v[32:35]
ds_read_b64 v[84:85], v4 offset:4096
v_mfma_f32_16x16x32_bf16 v[32:35], v[192:195], v[116:119], v[32:35]
ds_read_b64 v[86:87], v5 offset:4096
v_cvt_pk_bf16_f32 v76, v244, v245
s_waitcnt lgkmcnt(3)
v_mfma_f32_16x16x32_bf16 v[32:35], v[136:139], v[120:123], v[32:35]
ds_read_b128 v[88:91], v11 offset:3072
v_cvt_pk_bf16_f32 v77, v246, v247
v_mfma_f32_16x16x32_bf16 v[32:35], v[140:143], v[124:127], v[32:35]
ds_read_b128 v[92:95], v22 offset:3072
v_cvt_pk_bf16_f32 v78, v248, v249
v_mfma_f32_16x16x32_bf16 v[32:35], v[144:147], v[128:131], v[32:35]
ds_read_b64 v[96:97], v6 offset:4096
v_cvt_pk_bf16_f32 v79, v250, v251
v_mfma_f32_16x16x32_bf16 v[36:39], v[196:199], v[108:111], 0
ds_read_b64 v[98:99], v7 offset:4096
buffer_store_dwordx4 v[76:79], v1, s[44:47], s34 offen sc1
v_mfma_f32_16x16x32_bf16 v[36:39], v[200:203], v[112:115], v[36:39]
ds_read_b128 v[100:103], v23 offset:3072
s_mov_b64 exec, s[30:31]
ds_write_b128 v27, v[76:79] offset:0
s_mov_b64 exec, -1
v_mfma_f32_16x16x32_bf16 v[36:39], v[204:207], v[116:119], v[36:39]
v_cvt_pk_bf16_f32 v12, v252, v253
v_mfma_f32_16x16x32_bf16 v[36:39], v[148:151], v[120:123], v[36:39]
v_cvt_pk_bf16_f32 v13, v254, v255
v_mfma_f32_16x16x32_bf16 v[36:39], v[152:155], v[124:127], v[36:39]
v_cvt_pk_bf16_f32 v14, v104, v105
v_mfma_f32_16x16x32_bf16 v[36:39], v[156:159], v[128:131], v[36:39]
v_cvt_pk_bf16_f32 v15, v106, v107
v_mfma_f32_16x16x32_bf16 v[40:43], v[208:211], v[108:111], 0
buffer_store_dwordx4 v[12:15], v25, s[44:47], s35 offen sc1
v_mfma_f32_16x16x32_bf16 v[40:43], v[212:215], v[112:115], v[40:43]
v_mfma_f32_16x16x32_bf16 v[40:43], v[216:219], v[116:119], v[40:43]
v_mfma_f32_16x16x32_bf16 v[40:43], v[160:163], v[120:123], v[40:43]
v_mfma_f32_16x16x32_bf16 v[40:43], v[164:167], v[124:127], v[40:43]
v_mfma_f32_16x16x32_bf16 v[40:43], v[168:171], v[128:131], v[40:43]
v_cvt_pk_bf16_f32 v76, v32, v33
v_cvt_pk_bf16_f32 v77, v34, v35
v_mfma_f32_16x16x32_bf16 v[44:47], v[220:223], v[108:111], 0
v_cvt_pk_bf16_f32 v78, v36, v37
v_cvt_pk_bf16_f32 v79, v38, v39
v_mfma_f32_16x16x32_bf16 v[44:47], v[224:227], v[112:115], v[44:47]
buffer_store_dwordx4 v[76:79], v1, s[44:47], s36 offen sc1
s_mov_b64 exec, s[30:31]
ds_write_b128 v27, v[76:79] offset:1024
s_mov_b64 exec, -1
v_mfma_f32_16x16x32_bf16 v[44:47], v[228:231], v[116:119], v[44:47]
v_mfma_f32_16x16x32_bf16 v[44:47], v[172:175], v[120:123], v[44:47]
v_mfma_f32_16x16x32_bf16 v[44:47], v[176:179], v[124:127], v[44:47]
v_mfma_f32_16x16x32_bf16 v[44:47], v[180:183], v[128:131], v[44:47]
s_waitcnt lgkmcnt(4)
v_mfma_f32_16x16x32_bf16 v[244:247], v[184:187], v[80:83], 0
v_mfma_f32_16x16x32_bf16 v[244:247], v[188:191], v[84:87], v[244:247]
v_mfma_f32_16x16x32_bf16 v[244:247], v[192:195], v[88:91], v[244:247]
v_cvt_pk_bf16_f32 v12, v40, v41
s_waitcnt lgkmcnt(0)
v_mfma_f32_16x16x32_bf16 v[244:247], v[136:139], v[92:95], v[244:247]
v_cvt_pk_bf16_f32 v13, v42, v43
v_mfma_f32_16x16x32_bf16 v[244:247], v[140:143], v[96:99], v[244:247]
v_cvt_pk_bf16_f32 v14, v44, v45
v_mfma_f32_16x16x32_bf16 v[244:247], v[144:147], v[100:103], v[244:247]
v_cvt_pk_bf16_f32 v15, v46, v47
v_mfma_f32_16x16x32_bf16 v[248:251], v[196:199], v[80:83], 0
buffer_store_dwordx4 v[12:15], v25, s[44:47], s37 offen sc1
v_mfma_f32_16x16x32_bf16 v[248:251], v[200:203], v[84:87], v[248:251]
v_mfma_f32_16x16x32_bf16 v[248:251], v[204:207], v[88:91], v[248:251]
v_mfma_f32_16x16x32_bf16 v[248:251], v[148:151], v[92:95], v[248:251]
v_mfma_f32_16x16x32_bf16 v[248:251], v[152:155], v[96:99], v[248:251]
v_mfma_f32_16x16x32_bf16 v[248:251], v[156:159], v[100:103], v[248:251]
v_mfma_f32_16x16x32_bf16 v[252:255], v[208:211], v[80:83], 0
v_mfma_f32_16x16x32_bf16 v[252:255], v[212:215], v[84:87], v[252:255]
v_mfma_f32_16x16x32_bf16 v[252:255], v[216:219], v[88:91], v[252:255]
s_barrier
ds_read_b128 v[108:111], v18 offset:0
v_mfma_f32_16x16x32_bf16 v[252:255], v[160:163], v[92:95], v[252:255]
ds_read_b128 v[112:115], v18 offset:2048
v_mfma_f32_16x16x32_bf16 v[252:255], v[164:167], v[96:99], v[252:255]
ds_read_b128 v[116:119], v18 offset:4096
v_cvt_pk_bf16_f32 v76, v244, v245
v_mfma_f32_16x16x32_bf16 v[252:255], v[168:171], v[100:103], v[252:255]
ds_read_b64_tr_b16 v[120:121], v20 offset:49152
v_cvt_pk_bf16_f32 v77, v246, v247
v_mfma_f32_16x16x32_bf16 v[104:107], v[220:223], v[80:83], 0
ds_read_b64_tr_b16 v[122:123], v20 offset:49664
v_cvt_pk_bf16_f32 v78, v248, v249
v_mfma_f32_16x16x32_bf16 v[104:107], v[224:227], v[84:87], v[104:107]
ds_read_b64_tr_b16 v[124:125], v20 offset:0
v_cvt_pk_bf16_f32 v79, v250, v251
v_mfma_f32_16x16x32_bf16 v[104:107], v[228:231], v[88:91], v[104:107]
ds_read_b64_tr_b16 v[126:127], v20 offset:512
buffer_store_dwordx4 v[76:79], v1, s[44:47], s38 offen sc1
v_mfma_f32_16x16x32_bf16 v[104:107], v[172:175], v[92:95], v[104:107]
ds_read_b128 v[48:51], v19 offset:0
s_mov_b64 exec, s[30:31]
ds_write_b128 v27, v[76:79] offset:2048
s_mov_b64 exec, -1
v_mfma_f32_16x16x32_bf16 v[104:107], v[176:179], v[96:99], v[104:107]
ds_read_b128 v[52:55], v19 offset:2048
v_mfma_f32_16x16x32_bf16 v[104:107], v[180:183], v[100:103], v[104:107]
ds_read_b128 v[56:59], v19 offset:4096
s_waitcnt lgkmcnt(3)
v_mfma_f32_16x16x32_bf16 v[232:235], v[108:111], v[120:123], 0
s_waitcnt vmcnt(3)
buffer_atomic_add v29, v28, s[44:47], 0 offen offset:0 sc1
ds_read_b64_tr_b16 v[60:61], v20 offset:53248
ds_read_b64_tr_b16 v[62:63], v20 offset:53760
v_mfma_f32_16x16x32_bf16 v[236:239], v[112:115], v[120:123], 0
ds_read_b64_tr_b16 v[64:65], v20 offset:4096
v_cvt_pk_bf16_f32 v12, v252, v253
v_mfma_f32_16x16x32_bf16 v[240:243], v[116:119], v[120:123], 0
ds_read_b64_tr_b16 v[66:67], v20 offset:4608
ds_read_b128 v[80:83], v18 offset:12288
v_cvt_pk_bf16_f32 v13, v254, v255
v_mfma_f32_16x16x32_bf16 v[32:35], v[108:111], v[124:127], 0
ds_read_b128 v[84:87], v18 offset:14336
v_cvt_pk_bf16_f32 v14, v104, v105
v_mfma_f32_16x16x32_bf16 v[36:39], v[112:115], v[124:127], 0
ds_read_b128 v[88:91], v18 offset:16384
ds_read_b64_tr_b16 v[92:93], v20 offset:57344
v_cvt_pk_bf16_f32 v15, v106, v107
v_mfma_f32_16x16x32_bf16 v[40:43], v[116:119], v[124:127], 0
ds_read_b64_tr_b16 v[94:95], v20 offset:57856
buffer_store_dwordx4 v[12:15], v25, s[44:47], s39 offen sc1
s_waitcnt lgkmcnt(5)
v_mfma_f32_16x16x32_bf16 v[232:235], v[48:51], v[60:63], v[232:235]
ds_read_b64_tr_b16 v[96:97], v20 offset:8192
ds_read_b64_tr_b16 v[98:99], v20 offset:8704
v_mfma_f32_16x16x32_bf16 v[236:239], v[52:55], v[60:63], v[236:239]
ds_read_b128 v[100:103], v19 offset:12288
v_mfma_f32_16x16x32_bf16 v[240:243], v[56:59], v[60:63], v[240:243]
ds_read_b128 v[128:131], v19 offset:14336
ds_read_b128 v[132:135], v19 offset:16384
v_mfma_f32_16x16x32_bf16 v[32:35], v[48:51], v[64:67], v[32:35]
ds_read_b64_tr_b16 v[68:69], v20 offset:61440
v_mfma_f32_16x16x32_bf16 v[36:39], v[52:55], v[64:67], v[36:39]
ds_read_b64_tr_b16 v[70:71], v20 offset:61952
ds_read_b64_tr_b16 v[72:73], v20 offset:12288
v_mfma_f32_16x16x32_bf16 v[40:43], v[56:59], v[64:67], v[40:43]
ds_read_b64_tr_b16 v[74:75], v20 offset:12800
s_waitcnt lgkmcnt(7)
v_mfma_f32_16x16x32_bf16 v[232:235], v[80:83], v[92:95], v[232:235]
ds_read_b128 v[108:111], v24 offset:0
ds_read_b64 v[112:113], v8 offset:1024
v_mfma_f32_16x16x32_bf16 v[236:239], v[84:87], v[92:95], v[236:239]
ds_read_b64 v[114:115], v9 offset:1024
v_mfma_f32_16x16x32_bf16 v[240:243], v[88:91], v[92:95], v[240:243]
ds_read_b128 v[116:119], v21 offset:0
s_waitcnt lgkmcnt(4)
v_mfma_f32_16x16x32_bf16 v[232:235], v[100:103], v[68:71], v[232:235]
ds_read_b128 v[120:123], v24 offset:1536
v_mfma_f32_16x16x32_bf16 v[236:239], v[128:131], v[68:71], v[236:239]
ds_read_b64 v[124:125], v8 offset:2560
ds_read_b64 v[126:127], v9 offset:2560
v_mfma_f32_16x16x32_bf16 v[240:243], v[132:135], v[68:71], v[240:243]
ds_read_b128 v[48:51], v21 offset:1536
v_mfma_f32_16x16x32_bf16 v[32:35], v[80:83], v[96:99], v[32:35]
ds_read_b128 v[52:55], v24 offset:3072
v_mfma_f32_16x16x32_bf16 v[36:39], v[84:87], v[96:99], v[36:39]
ds_read_b64 v[56:57], v8 offset:4096
s_waitcnt vmcnt(3)
buffer_atomic_add v29, v28, s[44:47], 0 offen offset:128 sc1
v_mfma_f32_16x16x32_bf16 v[40:43], v[88:91], v[96:99], v[40:43]
ds_read_b64 v[58:59], v9 offset:4096
v_mfma_f32_16x16x32_bf16 v[32:35], v[100:103], v[72:75], v[32:35]
ds_read_b128 v[60:63], v21 offset:3072
v_cvt_pk_bf16_f32 v232, v232, v233
v_cvt_pk_bf16_f32 v233, v234, v235
v_mfma_f32_16x16x32_bf16 v[36:39], v[128:131], v[72:75], v[36:39]
v_cvt_pk_bf16_f32 v234, v236, v237
v_cvt_pk_bf16_f32 v235, v238, v239
v_mfma_f32_16x16x32_bf16 v[40:43], v[132:135], v[72:75], v[40:43]
v_cvt_pk_bf16_f32 v236, v240, v241
v_cvt_pk_bf16_f32 v237, v242, v243
s_waitcnt lgkmcnt(0)
v_mfma_f32_16x16x32_bf16 v[244:247], v[232:235], v[108:111], 0
v_cvt_pk_bf16_f32 v240, v32, v33
v_cvt_pk_bf16_f32 v241, v34, v35
v_mfma_f32_16x16x32_bf16 v[248:251], v[232:235], v[120:123], 0
v_cvt_pk_bf16_f32 v242, v36, v37
v_cvt_pk_bf16_f32 v243, v38, v39
v_mfma_f32_16x16x32_bf16 v[252:255], v[232:235], v[52:55], 0
v_cvt_pk_bf16_f32 v238, v40, v41
v_cvt_pk_bf16_f32 v239, v42, v43
v_mfma_f32_16x16x32_bf16 v[244:247], v[240:243], v[116:119], v[244:247]
s_nop 0
v_mfma_f32_16x16x32_bf16 v[244:247], v[236:239], v[112:115], v[244:247]
v_mfma_f32_16x16x32_bf16 v[248:251], v[240:243], v[48:51], v[248:251]
v_mfma_f32_16x16x32_bf16 v[248:251], v[236:239], v[124:127], v[248:251]
v_mfma_f32_16x16x32_bf16 v[252:255], v[240:243], v[60:63], v[252:255]
v_mfma_f32_16x16x32_bf16 v[252:255], v[236:239], v[56:59], v[252:255]
s_nop 3
v_cvt_pk_bf16_f32 v232, v244, v245
v_cvt_pk_bf16_f32 v233, v246, v247
buffer_store_dwordx2 v[232:233], v3, s[44:47], s58 offen sc1
v_cvt_pk_bf16_f32 v234, v248, v249
v_cvt_pk_bf16_f32 v235, v250, v251
buffer_store_dwordx2 v[234:235], v3, s[44:47], s56 offen sc1
v_cvt_pk_bf16_f32 v236, v252, v253
v_cvt_pk_bf16_f32 v237, v254, v255
buffer_store_dwordx2 v[236:237], v3, s[44:47], s57 offen sc1
s_mov_b64 exec, 0xfc
buffer_atomic_add v29, v30, s[44:47], 0 offen offset:256 sc1
s_mov_b64 exec, -1
s_waitcnt lgkmcnt(0)
s_waitcnt vmcnt(5)
buffer_atomic_add v29, v28, s[44:47], 0 offen offset:256 sc1
s_waitcnt vmcnt(2)
s_mov_b64 exec, 4
buffer_atomic_add v29, v30, s[44:47], 0 offen offset:320 sc1
s_mov_b64 exec, -1
s_endpgm
L_help:
s_sub_u32 s18, s20, 5
s_sub_u32 s52, s20, 1
v_lshlrev_b32 v25, 4, v0
v_lshlrev_b32 v26, 3, v0
v_mov_b32 v12, 0
v_mov_b32 v13, 0
v_mov_b32 v14, 0
v_mov_b32 v15, 0
v_mov_b32 v29, 1
v_mov_b32 v28, 0x7ff00000
v_mov_b32 v30, v28
v_mov_b32 v3, v28
s_waitcnt lgkmcnt(0)
s_mov_b32 s44, s14
s_mov_b32 s45, s15
s_mov_b32 s46, 268435456
s_mov_b32 s47, 0x20000
s_cmp_eq_u32 s20, 7
s_cbranch_scc1 L_h2
s_cmp_eq_u32 s20, 5
s_cbranch_scc1 L_h0
s_cmp_ge_u32 s2, 32
s_cbranch_scc1 L_h0
s_lshl_b32 s3, s2, 12
buffer_store_dwordx4 v[12:15], v25, s[44:47], s3 offen offset:0 sc1
buffer_store_dwordx4 v[12:15], v25, s[44:47], s3 offen offset:1024 sc1
buffer_store_dwordx4 v[12:15], v25, s[44:47], s3 offen offset:2048 sc1
buffer_store_dwordx4 v[12:15], v25, s[44:47], s3 offen offset:3072 sc1
s_waitcnt vmcnt(0)
s_mov_b64 exec, 1
global_atomic_add v12, v29, s[12:13] sc1
s_mov_b64 exec, -1
L_h0:
s_cmp_ge_u32 s52, 3
s_cselect_b32 s3, 12288, 0
s_add_u32 s3, s3, 73728
v_xor_b32 v7, v1, v2
v_lshlrev_b32 v7, 4, v7
v_lshl_add_u32 v7, v1, 8, v7
v_xor_b32 v8, 0, v7
v_add_u32 v184, s3, v8
v_xor_b32 v8, 64, v7
v_add_u32 v185, s3, v8
v_xor_b32 v8, 128, v7
v_add_u32 v186, s3, v8
v_xor_b32 v8, 192, v7
v_add_u32 v187, s3, v8
s_lshl_b32 s3, s52, 12
s_add_u32 s3, s3, 49152
v_add_u32 v254, s3, v25
s_mov_b32 s50, 0x3e0293ee
s_mov_b32 s51, s50
s_mul_i32 s3, s52, 1536
s_mul_i32 s49, s2, 9216
s_add_u32 s49, s49, s3
s_add_u32 s49, s49, 262144
s_add_u32 s3, s3, 101376
v_add_u32 v255, s3, v25
v_add_u32 v31, s3, v26
s_barrier
s_barrier
s_barrier
s_barrier
s_barrier
s_barrier
s_barrier
s_barrier
s_barrier
s_branch L_unit
L_h2:
s_mov_b64 exec, 0
s_branch L_dry_mp
L_dryret_mp:
s_mov_b64 exec, -1
s_barrier
s_mov_b64 vcc, 0
s_mov_b32 s63, 1
s_mov_b64 exec, 0
s_branch L_dry_op
L_dryret_op:
s_mov_b64 exec, -1
s_barrier
s_barrier
s_barrier
s_barrier
s_barrier
s_barrier
s_barrier
s_barrier
s_load_dword s84, s[12:13], 0
s_lshl_b32 s3, s21, 1
s_lshr_b32 s17, s2, 7
s_lshl_b32 s17, s17, 0
s_add_u32 s3, s3, s17
s_lshl_b32 s3, s3, 4
s_bfe_u32 s17, s2, 0x40003
s_add_u32 s3, s3, s17
s_mul_i32 s3, s3, 18432
s_add_u32 s3, s3, 1024
v_mul_u32_u24 v7, 1152, v1
v_add_u32 v7, s3, v7
s_mov_b64 exec, 0xffff
global_load_dword v37, v7, s[8:9]
s_mov_b64 exec, -1
s_barrier
s_waitcnt lgkmcnt(0)
s_cmp_ge_u32 s84, 32
s_cbranch_scc1 L_hsok
s_mov_b32 s54, 65536
v_mov_b32 v12, 0
L_hs:
global_load_dword v13, v12, s[12:13] sc1
s_sub_u32 s54, s54, 1
s_cbranch_scc1 L_hsok
s_waitcnt vmcnt(0)
v_cmp_gt_u32 vcc, 32, v13
s_cbranch_vccnz L_hs
L_hsok:
s_barrier
L_help2:
s_mul_i32 s17, s18, 3072
s_mov_b32 s48, s10
s_mov_b32 s49, s11
s_mov_b32 s50, 884736
s_mov_b32 s51, 0x20000
s_lshl_b32 s3, s2, 9
s_lshl_b32 s53, s18, 7
s_add_u32 s62, s3, s53
s_add_u32 s66, s14, s62
s_addc_u32 s67, s15, 0
s_and_b32 s3, s2, 0xe7
s_lshl_b32 s3, s3, 9
s_add_u32 s53, s53, s3
v_lshlrev_b32 v21, 12, v0
s_mul_i32 s55, s2, 21504
s_mul_i32 s56, s18, 7168
s_add_u32 s55, s55, s56
s_add_u32 s55, s55, 4194304
s_add_u32 s56, s55, 4096
s_lshl_b32 s59, s23, 1
s_lshr_b32 s3, s21, 2
s_add_u32 s59, s59, s3
s_mul_i32 s59, s59, 3
s_add_u32 s59, s59, s18
s_mul_i32 s59, s59, 18432
s_lshl_b32 s3, s22, 8
s_add_u32 s59, s59, s3
s_and_b32 s3, s21, 3
s_lshl_b32 s3, s3, 6
s_add_u32 s59, s59, s3
s_waitcnt vmcnt(0)
s_barrier
s_mov_b64 exec, 15
s_bitset0_b64 exec, s22
buffer_atomic_add v29, v21, s[44:47], s53 offen sc1
s_mov_b64 exec, -1
s_barrier
s_barrier
s_mov_b32 s54, 65536
s_mov_b32 s52, 3
L_pp:
s_load_dword s84, s[66:67], 0 glc
s_cmp_eq_u32 s52, 0
s_cbranch_scc1 L_pp1
s_barrier
s_sub_u32 s52, s52, 1
L_pp1:
s_sub_u32 s54, s54, 1
s_cbranch_scc1 L_ppok
s_waitcnt lgkmcnt(0)
s_cmp_ge_u32 s84, 3
s_cbranch_scc0 L_pp
L_ppok:
s_add_u32 m0, s17, 92160
s_xor_b32 s58, s2, 8
s_mul_i32 s58, s58, 9216
s_add_u32 s58, s58, s17
s_add_u32 s58, s58, 262144
buffer_load_dwordx4 v25, s[44:47], s58 offen offset:0 sc1 lds
buffer_load_dwordx4 v25, s[44:47], s58 offen offset:1024 sc1 lds
buffer_load_dwordx4 v25, s[44:47], s58 offen offset:2048 sc1 lds
s_add_u32 m0, s17, 82944
s_xor_b32 s58, s2, 16
s_mul_i32 s58, s58, 9216
s_add_u32 s58, s58, s17
s_add_u32 s58, s58, 262144
buffer_load_dwordx4 v25, s[44:47], s58 offen offset:0 sc1 lds
buffer_load_dwordx4 v25, s[44:47], s58 offen offset:1024 sc1 lds
buffer_load_dwordx4 v25, s[44:47], s58 offen offset:2048 sc1 lds
s_add_u32 m0, s17, 73728
s_xor_b32 s58, s2, 24
s_mul_i32 s58, s58, 9216
s_add_u32 s58, s58, s17
s_add_u32 s58, s58, 262144
buffer_load_dwordx4 v25, s[44:47], s58 offen offset:0 sc1 lds
buffer_load_dwordx4 v25, s[44:47], s58 offen offset:1024 sc1 lds
buffer_load_dwordx4 v25, s[44:47], s58 offen offset:2048 sc1 lds
L_pb:
s_cmp_eq_u32 s52, 0
s_cbranch_scc1 L_pbd
s_barrier
s_sub_u32 s52, s52, 1
s_branch L_pb
L_pbd:
s_waitcnt vmcnt(0)
s_barrier
s_lshl_b32 s3, s23, 1
s_and_b32 s58, s22, 1
s_add_u32 s3, s3, s58
s_mul_i32 s3, s3, 3
s_add_u32 s3, s3, s18
s_mul_i32 s58, s3, 32768
s_lshl_b32 s3, s21, 1
s_lshr_b32 s57, s22, 1
s_add_u32 s3, s3, s57
s_lshl_b32 s3, s3, 9
s_add_u32 s58, s58, s3
s_add_u32 s58, s58, 13631488
v_and_b32 v4, 31, v0
v_lshrrev_b32 v5, 5, v0
v_mul_u32_u24 v5, 8192, v5
v_lshl_add_u32 v4, v4, 4, v5
v_mov_b32 v12, -1
v_mov_b32 v13, -1
v_mov_b32 v14, -1
v_mov_b32 v15, -1
buffer_store_dwordx4 v[12:15], v4, s[44:47], s58 offen sc1
s_add_u32 s58, s58, 16384
buffer_store_dwordx4 v[12:15], v4, s[44:47], s58 offen sc1
s_waitcnt vmcnt(0)
s_barrier
s_mov_b32 s54, 65536
s_lshl_b32 s3, s18, 10
s_add_u32 s3, s3, 159744
v_add_u32 v27, s3, v25
s_andn2_b32 s62, s62, 512
s_add_u32 s66, s14, s62
s_addc_u32 s67, s15, 0
v_mul_u32_u24 v3, 1152, v1
v_lshl_add_u32 v3, v2, 4, v3
s_mov_b32 s29, 0xffff0000
L_mp:
s_load_dword s84, s[66:67], 64 glc
s_sub_u32 s54, s54, 1
s_cbranch_scc1 L_mpok
s_waitcnt lgkmcnt(0)
s_cmp_lt_u32 s84, 8
s_cbranch_scc1 L_mp
L_mpok:
buffer_load_dwordx4 v[36:39], v25, s[44:47], s55 offen offset:1024 sc1
buffer_load_dwordx4 v[40:43], v25, s[44:47], s55 offen offset:2048 sc1
buffer_load_dwordx4 v[44:47], v25, s[44:47], s55 offen offset:3072 sc1
buffer_load_dwordx4 v[48:51], v25, s[44:47], s56 offen offset:0 sc1
buffer_load_dwordx4 v[52:55], v25, s[44:47], s56 offen offset:1024 sc1
buffer_load_dwordx4 v[56:59], v25, s[44:47], s56 offen offset:2048 sc1
buffer_load_dwordx4 v[60:63], v25, s[44:47], s56 offen offset:3072 sc1
ds_read_b128 v[32:35], v27
L_dry_mp:
s_waitcnt lgkmcnt(0)
v_lshlrev_b32 v8, 16, v32
v_lshlrev_b32 v9, 16, v33
v_lshlrev_b32 v10, 16, v34
v_lshlrev_b32 v11, 16, v35
v_and_b32 v12, s29, v32
v_and_b32 v13, s29, v33
v_and_b32 v14, s29, v34
v_and_b32 v15, s29, v35
s_waitcnt vmcnt(6)
v_lshlrev_b32 v20, 16, v36
v_lshlrev_b32 v21, 16, v37
v_lshlrev_b32 v22, 16, v38
v_lshlrev_b32 v23, 16, v39
v_and_b32 v36, s29, v36
v_and_b32 v37, s29, v37
v_and_b32 v38, s29, v38
v_and_b32 v39, s29, v39
v_pk_add_f32 v[8:9], v[8:9], v[20:21]
v_pk_add_f32 v[10:11], v[10:11], v[22:23]
v_pk_add_f32 v[12:13], v[12:13], v[36:37]
v_pk_add_f32 v[14:15], v[14:15], v[38:39]
s_waitcnt vmcnt(5)
v_lshlrev_b32 v16, 16, v40
v_lshlrev_b32 v17, 16, v41
v_lshlrev_b32 v18, 16, v42
v_lshlrev_b32 v19, 16, v43
v_and_b32 v40, s29, v40
v_and_b32 v41, s29, v41
v_and_b32 v42, s29, v42
v_and_b32 v43, s29, v43
v_pk_add_f32 v[8:9], v[8:9], v[16:17]
v_pk_add_f32 v[10:11], v[10:11], v[18:19]
v_pk_add_f32 v[12:13], v[12:13], v[40:41]
v_pk_add_f32 v[14:15], v[14:15], v[42:43]
s_waitcnt vmcnt(4)
v_lshlrev_b32 v20, 16, v44
v_lshlrev_b32 v21, 16, v45
v_lshlrev_b32 v22, 16, v46
v_lshlrev_b32 v23, 16, v47
v_and_b32 v44, s29, v44
v_and_b32 v45, s29, v45
v_and_b32 v46, s29, v46
v_and_b32 v47, s29, v47
v_pk_add_f32 v[8:9], v[8:9], v[20:21]
v_pk_add_f32 v[10:11], v[10:11], v[22:23]
v_pk_add_f32 v[12:13], v[12:13], v[44:45]
v_pk_add_f32 v[14:15], v[14:15], v[46:47]
s_waitcnt vmcnt(3)
v_lshlrev_b32 v16, 16, v48
v_lshlrev_b32 v17, 16, v49
v_lshlrev_b32 v18, 16, v50
v_lshlrev_b32 v19, 16, v51
v_and_b32 v48, s29, v48
v_and_b32 v49, s29, v49
v_and_b32 v50, s29, v50
v_and_b32 v51, s29, v51
v_pk_add_f32 v[8:9], v[8:9], v[16:17]
v_pk_add_f32 v[10:11], v[10:11], v[18:19]
v_pk_add_f32 v[12:13], v[12:13], v[48:49]
v_pk_add_f32 v[14:15], v[14:15], v[50:51]
s_waitcnt vmcnt(2)
v_lshlrev_b32 v20, 16, v52
v_lshlrev_b32 v21, 16, v53
v_lshlrev_b32 v22, 16, v54
v_lshlrev_b32 v23, 16, v55
v_and_b32 v52, s29, v52
v_and_b32 v53, s29, v53
v_and_b32 v54, s29, v54
v_and_b32 v55, s29, v55
v_pk_add_f32 v[8:9], v[8:9], v[20:21]
v_pk_add_f32 v[10:11], v[10:11], v[22:23]
v_pk_add_f32 v[12:13], v[12:13], v[52:53]
v_pk_add_f32 v[14:15], v[14:15], v[54:55]
s_waitcnt vmcnt(1)
v_lshlrev_b32 v16, 16, v56
v_lshlrev_b32 v17, 16, v57
v_lshlrev_b32 v18, 16, v58
v_lshlrev_b32 v19, 16, v59
v_and_b32 v56, s29, v56
v_and_b32 v57, s29, v57
v_and_b32 v58, s29, v58
v_and_b32 v59, s29, v59
v_pk_add_f32 v[8:9], v[8:9], v[16:17]
v_pk_add_f32 v[10:11], v[10:11], v[18:19]
v_pk_add_f32 v[12:13], v[12:13], v[56:57]
v_pk_add_f32 v[14:15], v[14:15], v[58:59]
s_waitcnt vmcnt(0)
v_lshlrev_b32 v20, 16, v60
v_lshlrev_b32 v21, 16, v61
v_lshlrev_b32 v22, 16, v62
v_lshlrev_b32 v23, 16, v63
v_and_b32 v60, s29, v60
v_and_b32 v61, s29, v61
v_and_b32 v62, s29, v62
v_and_b32 v63, s29, v63
v_pk_add_f32 v[8:9], v[8:9], v[20:21]
v_pk_add_f32 v[10:11], v[10:11], v[22:23]
v_pk_add_f32 v[12:13], v[12:13], v[60:61]
v_pk_add_f32 v[14:15], v[14:15], v[62:63]
v_cvt_pk_bf16_f32 v8, v8, v12
v_cvt_pk_bf16_f32 v9, v9, v13
v_cvt_pk_bf16_f32 v10, v10, v14
v_cvt_pk_bf16_f32 v11, v11, v15
s_nop 0
v_permlane32_swap_b32 v8, v10
v_permlane32_swap_b32 v9, v11
s_nop 0
v_permlane16_swap_b32 v8, v10
v_permlane16_swap_b32 v9, v11
s_cbranch_execz L_dryret_mp
buffer_store_dwordx4 v[8:11], v3, s[48:51], s59 offen sc1
L_end:
s_endpgm
L_codeend:
.section .rodata,"a"
.p2align 6
.amdhsa_kernel standalone__gqa_block_cached__near_ridge_kernel
  .amdhsa_next_free_vgpr 256
  .amdhsa_next_free_sgpr 102
  .amdhsa_accum_offset 256
  .amdhsa_group_segment_fixed_size 0
  .amdhsa_kernarg_size 64
  .amdhsa_user_sgpr_count 2
  .amdhsa_user_sgpr_kernarg_segment_ptr 1
  .amdhsa_system_sgpr_workgroup_id_x 1
  .amdhsa_float_denorm_mode_32 3
.end_amdhsa_kernel
.text
```
